```python
import torch

def _softmax(x, axis=-1):
    return torch.softmax(x, dim=axis)
def _gelu(x):
    return torch.nn.functional.gelu(x, approximate="tanh")
def _silu(x):
    return torch.nn.functional.silu(x)
def _sigmoid(x):
    return torch.sigmoid(x)
def _layernorm(x, axis=-1, eps=1e-5):
    m = x.mean(dim=axis, keepdim=True)
    v = x.var(dim=axis, keepdim=True, unbiased=False)
    return (x - m) / torch.sqrt(v + eps)
def _scatter_add(tgt, idx, src, axis=0):
    return tgt.clone().index_add_(axis, idx, src)
def _segment_sum(src, seg, n):
    out = torch.zeros((n,) + src.shape[1:], dtype=src.dtype)
    return out.index_add_(0, seg, src)
def _pad(x, pw):
    flat = tuple(v for pair in reversed(pw) for v in pair)
    return torch.nn.functional.pad(x, flat)

kernel_name = 'concat_heads__grouped_kv_mqa__spectral_fnet__prompt'

def setup_inputs():

    _w = (lambda a: (lambda t: t.to(torch.bfloat16) if t.is_floating_point() else t)(torch.as_tensor(a)))
    def _A_setup():
        B, S, D, H = 1, 2048, 512, 32
        Dh = D // H
        return {
            "x": _w((lambda *s: torch.randn(*s, dtype=torch.bfloat16) * 0.05)(B, S, D)),
            "wq": _w((lambda *s: torch.randn(*s, dtype=torch.bfloat16) * 3.2)(D, H * Dh)),
            "wk": _w((lambda *s: torch.randn(*s, dtype=torch.bfloat16) * 3.2)(D, Dh)),
            "wv": _w((lambda *s: torch.randn(*s, dtype=torch.bfloat16) * 1.6)(D, Dh)),
            "wo": _w((lambda *s: torch.randn(*s, dtype=torch.bfloat16) * 1.6)(H * Dh, D)),
        }
    _A_in = _A_setup()

    def _B_setup():
        B, S, D = 1, 2048, 512
        ns = torch.arange(S)[:, None] * torch.arange(S)[None, :]
        nd = torch.arange(D)[:, None] * torch.arange(D)[None, :]
        Ws_re = torch.cos(-2.0 * torch.pi * ns / S).to(float)
        Ws_im = torch.sin(-2.0 * torch.pi * ns / S).to(float)
        Wd_re = torch.cos(-2.0 * torch.pi * nd / D).to(float)
        Wd_im = torch.sin(-2.0 * torch.pi * nd / D).to(float)
        return {
            "x": _w((lambda *s: torch.randn(*s, dtype=torch.bfloat16) * 0.05)(B, S, D)),
            "dft_seq_re": _w(Ws_re),
            "dft_seq_im": _w(Ws_im),
            "dft_hid_re": _w(Wd_re),
            "dft_hid_im": _w(Wd_im),
        }
    _B_in = _B_setup()

    return {
        "A_x": _A_in["x"],
        "A_wq": _A_in["wq"],
        "A_wk": _A_in["wk"],
        "A_wv": _A_in["wv"],
        "A_wo": _A_in["wo"],
        "B_x": _B_in["x"],
        "B_dft_seq_re": _B_in["dft_seq_re"],
        "B_dft_seq_im": _B_in["dft_seq_im"],
        "B_dft_hid_re": _B_in["dft_hid_re"],
        "B_dft_hid_im": _B_in["dft_hid_im"],
    }

def reference(A_x, A_wq, A_wk, A_wv, A_wo, B_x, B_dft_seq_re, B_dft_seq_im, B_dft_hid_re, B_dft_hid_im):
    def _A_ref(x, wq, wk, wv, wo):
        B, S, D = x.shape
        H = 32
        Dh = D // H
        q = (lambda x, *d: x.permute(*d))((x @ wq).reshape(B, S, H, Dh), 0, 2, 1, 3)
        k = x @ wk
        v = x @ wv
        scores = torch.einsum("bhqd,bkd->bhqk", q, k) * (Dh ** -0.5)
        p = _softmax(scores, axis=-1)
        o = torch.einsum("bhqk,bkd->bhqd", p, v)
        return (lambda x, *d: x.permute(*d))(o, 0, 2, 1, 3).reshape(B, S, H * Dh) @ wo

    def _B_ref(x, dft_seq_re, dft_seq_im, dft_hid_re, dft_hid_im):
        a = torch.einsum("bsd,ed->bse", x, dft_hid_re)
        b = torch.einsum("bsd,ed->bse", x, dft_hid_im)
        y = torch.einsum("ts,bse->bte", dft_seq_re, a) - torch.einsum("ts,bse->bte", dft_seq_im, b)
        return y

    a = _A_ref(A_x, A_wq, A_wk, A_wv, A_wo)
    b = _B_ref(B_x, B_dft_seq_re, B_dft_seq_im, B_dft_hid_re, B_dft_hid_im)
    return torch.concatenate([a, b], axis=-1)
```

```asm
; @launch grid=(256,1,1) block=(512,1,1) lds=163840
.amdgcn_target "amdgcn-amd-amdhsa--gfx950"
.text
.globl concat_heads__grouped_kv_mqa__spectral_fnet__prompt_kernel
.p2align 8
.type concat_heads__grouped_kv_mqa__spectral_fnet__prompt_kernel,@function
concat_heads__grouped_kv_mqa__spectral_fnet__prompt_kernel:
    s_cmp_ge_u32 s2, 256
    s_cbranch_scc1 L_end
    s_load_dwordx16 s[4:19], s[0:1], 0
    s_load_dwordx8 s[20:27], s[0:1], 64
    s_load_dwordx2 s[28:29], s[0:1], 96
    s_memrealtime s[86:87]
    v_lshrrev_b32 v2, 6, v0
    v_and_b32 v1, 63, v0
    v_readfirstlane_b32 s72, v2
    s_and_b32 s73, s2, 7
    s_lshr_b32 s74, s2, 3
    s_and_b32 s80, s74, 3
    s_lshl_b32 s75, s73, 2
    s_add_u32 s75, s75, s80
    s_lshr_b32 s76, s74, 2
    s_lshr_b32 s77, s76, 1
    s_and_b32 s78, s72, 3
    v_lshlrev_b32 v2, 4, v1
    v_lshrrev_b32 v5, 3, v0
    v_cmp_ne_u32 vcc, 8, v5
    v_and_b32 v4, 1, v0
    v_add_u32 v4, -1, v4
    v_and_b32 v4, 0x5f805f80, v4
    v_cndmask_b32 v4, 0, v4, vcc
    v_lshlrev_b32 v3, 4, v0
    v_mov_b32 v5, v4
    v_mov_b32 v6, v4
    v_mov_b32 v7, v4
    v_add_u32 v3, 155648, v3
    ds_write_b128 v3, v[4:7]
    s_mov_b32 s34, 0x200000
    s_mov_b32 s35, 0x20000
    s_cmp_lt_u32 s72, 4
    s_cbranch_scc1 L_att0
    s_setprio 2
    s_lshl_b32 s80, s77, 4
    s_lshl_b32 s81, s78, 2
    s_add_u32 s80, s80, s81
    s_mul_i32 s81, s80, 1040
    s_add_u32 s81, s81, 16384
    s_lshl_b32 s82, s75, 6
    s_add_u32 s82, s82, s80
    s_lshl_b32 s82, s82, 10
    s_lshl_b32 s83, s78, 12
    s_mov_b32 s42, 16384
    s_mov_b32 s43, 0x20000
    s_mov_b32 m0, s83
    s_bitcmp1_b32 s76, 0
    s_waitcnt lgkmcnt(0)
    s_cselect_b32 s40, s10, s8
    s_cselect_b32 s41, s11, s9
    s_and_b32 s41, s41, 0xffff
    s_mov_b32 s32, s4
    s_and_b32 s33, s5, 0xffff
    s_mov_b32 s68, s26
    s_and_b32 s69, s27, 0xffff
    s_mov_b32 s70, 0x100
    s_mov_b32 s71, 0x20000
    s_or_b32 s86, s86, 16
    s_and_b32 s86, s86, -16
    s_lshl_b32 s80, s2, 3
    s_add_u32 s80, s80, s72
    s_cmp_eq_u32 s80, 7
    s_cbranch_scc0 L_notag
    v_mov_b32 v4, s86
    v_mov_b32 v5, s87
    s_mov_b64 exec, 1
    buffer_store_dwordx2 v[4:5], off, s[68:71], 0 sc1
    s_mov_b64 exec, -1
L_notag:
    buffer_load_dwordx4 v2, s[40:43], s83 offen offset:0 lds
    buffer_load_dwordx4 v2, s[40:43], s83 offen offset:1024 lds
    buffer_load_dwordx4 v2, s[40:43], s83 offen offset:2048 lds
    buffer_load_dwordx4 v2, s[40:43], s83 offen offset:3072 lds
    s_mov_b32 m0, s81
    s_add_u32 s81, s81, 1040
    buffer_load_dwordx4 v2, s[32:35], s82 offen nt lds
    s_add_u32 s82, s82, 1024
    s_mov_b32 m0, s81
    s_add_u32 s81, s81, 1040
    buffer_load_dwordx4 v2, s[32:35], s82 offen nt lds
    s_add_u32 s82, s82, 1024
    s_mov_b32 m0, s81
    s_add_u32 s81, s81, 1040
    buffer_load_dwordx4 v2, s[32:35], s82 offen nt lds
    s_add_u32 s82, s82, 1024
    s_mov_b32 m0, s81
    s_nop 0
    buffer_load_dwordx4 v2, s[32:35], s82 offen nt lds
    s_mov_b32 s44, s28
    s_and_b32 s45, s29, 0xffff
    s_mov_b32 s46, 0x560000
    s_mov_b32 s47, 0x20000
    s_barrier
    s_branch L_aux
L_att0:
    v_lshrrev_b32 v3, 3, v1
    v_and_b32 v4, 7, v1
    v_bfe_u32 v5, v1, 4, 1
    v_lshlrev_b32 v5, 2, v5
    v_xor_b32 v4, v4, v5
    v_lshlrev_b32 v4, 4, v4
    v_lshl_add_u32 v13, v3, 10, v4
    s_mov_b32 s38, 0x80000
    s_mov_b32 s39, 0x20000
    s_add_u32 s80, s74, 0
    s_and_b32 s80, s80, 3
    s_lshl_b32 s80, s80, 2
    s_add_u32 s80, s80, s72
    s_lshl_b32 s82, s80, 15
    s_lshl_b32 s81, s76, 7
    s_add_u32 s82, s82, s81
    s_lshl_b32 s81, s80, 12
    s_add_u32 s81, s81, 82944
    s_waitcnt lgkmcnt(0)
    s_mov_b32 s36, s6
    s_and_b32 s37, s7, 0xffff
    s_mov_b32 s32, s4
    s_and_b32 s33, s5, 0xffff
    s_barrier
    s_mov_b32 m0, s81
    s_add_u32 s81, s81, 1024
    buffer_load_dwordx4 v13, s[36:39], s82 offen lds
    s_add_u32 s82, s82, 8192
    s_mov_b32 m0, s81
    s_add_u32 s81, s81, 1024
    buffer_load_dwordx4 v13, s[36:39], s82 offen lds
    s_add_u32 s82, s82, 8192
    s_mov_b32 m0, s81
    s_add_u32 s81, s81, 1024
    buffer_load_dwordx4 v13, s[36:39], s82 offen lds
    s_add_u32 s82, s82, 8192
    s_mov_b32 m0, s81
    s_nop 0
    buffer_load_dwordx4 v13, s[36:39], s82 offen lds
    s_add_u32 s80, s77, 1
    s_and_b32 s80, s80, 3
    s_lshl_b32 s80, s80, 2
    s_add_u32 s80, s80, s72
    s_lshl_b32 s80, s80, 2
    s_mul_i32 s81, s80, 1040
    s_add_u32 s81, s81, 16384
    s_lshl_b32 s82, s75, 6
    s_add_u32 s82, s82, s80
    s_lshl_b32 s82, s82, 10
    s_mov_b32 m0, s81
    s_add_u32 s81, s81, 1040
    buffer_load_dwordx4 v2, s[32:35], s82 offen nt lds
    s_add_u32 s82, s82, 1024
    s_mov_b32 m0, s81
    s_add_u32 s81, s81, 1040
    buffer_load_dwordx4 v2, s[32:35], s82 offen nt lds
    s_add_u32 s82, s82, 1024
    s_mov_b32 m0, s81
    s_add_u32 s81, s81, 1040
    buffer_load_dwordx4 v2, s[32:35], s82 offen nt lds
    s_add_u32 s82, s82, 1024
    s_mov_b32 m0, s81
    s_nop 0
    buffer_load_dwordx4 v2, s[32:35], s82 offen nt lds
    s_add_u32 s80, s77, 2
    s_and_b32 s80, s80, 3
    s_lshl_b32 s80, s80, 2
    s_add_u32 s80, s80, s72
    s_lshl_b32 s80, s80, 2
    s_mul_i32 s81, s80, 1040
    s_add_u32 s81, s81, 16384
    s_lshl_b32 s82, s75, 6
    s_add_u32 s82, s82, s80
    s_lshl_b32 s82, s82, 10
    s_waitcnt vmcnt(4)
    s_mov_b32 m0, s81
    s_add_u32 s81, s81, 1040
    buffer_load_dwordx4 v2, s[32:35], s82 offen nt lds
    s_add_u32 s82, s82, 1024
    s_mov_b32 m0, s81
    s_add_u32 s81, s81, 1040
    buffer_load_dwordx4 v2, s[32:35], s82 offen nt lds
    s_add_u32 s82, s82, 1024
    s_mov_b32 m0, s81
    s_add_u32 s81, s81, 1040
    buffer_load_dwordx4 v2, s[32:35], s82 offen nt lds
    s_add_u32 s82, s82, 1024
    s_mov_b32 m0, s81
    s_nop 0
    buffer_load_dwordx4 v2, s[32:35], s82 offen nt lds
    s_add_u32 s80, s77, 3
    s_and_b32 s80, s80, 3
    s_lshl_b32 s80, s80, 2
    s_add_u32 s80, s80, s72
    s_lshl_b32 s80, s80, 2
    s_mul_i32 s81, s80, 1040
    s_add_u32 s81, s81, 16384
    s_lshl_b32 s82, s75, 6
    s_add_u32 s82, s82, s80
    s_lshl_b32 s82, s82, 10
    s_waitcnt vmcnt(4)
    s_mov_b32 m0, s81
    s_add_u32 s81, s81, 1040
    buffer_load_dwordx4 v2, s[32:35], s82 offen nt lds
    s_add_u32 s82, s82, 1024
    s_mov_b32 m0, s81
    s_add_u32 s81, s81, 1040
    buffer_load_dwordx4 v2, s[32:35], s82 offen nt lds
    s_add_u32 s82, s82, 1024
    s_mov_b32 m0, s81
    s_add_u32 s81, s81, 1040
    buffer_load_dwordx4 v2, s[32:35], s82 offen nt lds
    s_add_u32 s82, s82, 1024
    s_mov_b32 m0, s81
    s_nop 0
    buffer_load_dwordx4 v2, s[32:35], s82 offen nt lds
    s_add_u32 s80, s74, 1
    s_and_b32 s80, s80, 3
    s_lshl_b32 s80, s80, 2
    s_add_u32 s80, s80, s72
    s_lshl_b32 s82, s80, 15
    s_lshl_b32 s81, s76, 7
    s_add_u32 s82, s82, s81
    s_lshl_b32 s81, s80, 12
    s_add_u32 s81, s81, 82944
    s_waitcnt vmcnt(4)
    s_mov_b32 m0, s81
    s_add_u32 s81, s81, 1024
    buffer_load_dwordx4 v13, s[36:39], s82 offen lds
    s_add_u32 s82, s82, 8192
    s_mov_b32 m0, s81
    s_add_u32 s81, s81, 1024
    buffer_load_dwordx4 v13, s[36:39], s82 offen lds
    s_add_u32 s82, s82, 8192
    s_mov_b32 m0, s81
    s_add_u32 s81, s81, 1024
    buffer_load_dwordx4 v13, s[36:39], s82 offen lds
    s_add_u32 s82, s82, 8192
    s_mov_b32 m0, s81
    s_nop 0
    buffer_load_dwordx4 v13, s[36:39], s82 offen lds
    s_add_u32 s80, s74, 2
    s_and_b32 s80, s80, 3
    s_lshl_b32 s80, s80, 2
    s_add_u32 s80, s80, s72
    s_lshl_b32 s82, s80, 15
    s_lshl_b32 s81, s76, 7
    s_add_u32 s82, s82, s81
    s_lshl_b32 s81, s80, 12
    s_add_u32 s81, s81, 82944
    s_waitcnt vmcnt(4)
    s_mov_b32 m0, s81
    s_add_u32 s81, s81, 1024
    buffer_load_dwordx4 v13, s[36:39], s82 offen lds
    s_add_u32 s82, s82, 8192
    s_mov_b32 m0, s81
    s_add_u32 s81, s81, 1024
    buffer_load_dwordx4 v13, s[36:39], s82 offen lds
    s_add_u32 s82, s82, 8192
    s_mov_b32 m0, s81
    s_add_u32 s81, s81, 1024
    buffer_load_dwordx4 v13, s[36:39], s82 offen lds
    s_add_u32 s82, s82, 8192
    s_mov_b32 m0, s81
    s_nop 0
    buffer_load_dwordx4 v13, s[36:39], s82 offen lds
    s_add_u32 s80, s74, 3
    s_and_b32 s80, s80, 3
    s_lshl_b32 s80, s80, 2
    s_add_u32 s80, s80, s72
    s_lshl_b32 s82, s80, 15
    s_lshl_b32 s81, s76, 7
    s_add_u32 s82, s82, s81
    s_lshl_b32 s81, s80, 12
    s_add_u32 s81, s81, 82944
    s_waitcnt vmcnt(4)
    s_mov_b32 m0, s81
    s_add_u32 s81, s81, 1024
    buffer_load_dwordx4 v13, s[36:39], s82 offen lds
    s_add_u32 s82, s82, 8192
    s_mov_b32 m0, s81
    s_add_u32 s81, s81, 1024
    buffer_load_dwordx4 v13, s[36:39], s82 offen lds
    s_add_u32 s82, s82, 8192
    s_mov_b32 m0, s81
    s_add_u32 s81, s81, 1024
    buffer_load_dwordx4 v13, s[36:39], s82 offen lds
    s_add_u32 s82, s82, 8192
    s_mov_b32 m0, s81
    s_nop 0
    buffer_load_dwordx4 v13, s[36:39], s82 offen lds
    s_mov_b32 s44, s28
    s_and_b32 s45, s29, 0xffff
    s_mov_b32 s46, 0x560000
    s_mov_b32 s47, 0x20000
    s_and_b32 s80, s72, 1
    s_lshr_b32 s81, s72, 1
    v_and_b32 v3, 31, v1
    s_lshl_b32 s82, s80, 5
    v_add_u32 v3, s82, v3
    v_mul_u32_u24 v3, 1040, v3
    v_lshrrev_b32 v4, 5, v1
    v_lshl_add_u32 v14, v4, 4, v3
    v_bfe_u32 v5, v1, 2, 2
    v_lshl_add_u32 v6, v4, 3, v5
    v_lshlrev_b32 v6, 7, v6
    v_bfe_u32 v7, v1, 4, 1
    v_and_b32 v8, 1, v1
    v_lshl_add_u32 v7, v7, 1, v8
    s_lshl_b32 s82, s81, 2
    v_add_u32 v7, s82, v7
    v_bfe_u32 v8, v1, 3, 1
    v_lshlrev_b32 v8, 2, v8
    v_xor_b32 v7, v7, v8
    v_lshl_add_u32 v6, v7, 4, v6
    v_bfe_u32 v8, v1, 1, 1
    v_lshl_add_u32 v6, v8, 3, v6
    v_add_u32 v149, 82944, v6
    v_add_u32 v148, 16384, v14
    v_mov_b32 v144, 0xdddddddd
    v_bfe_u32 v5, v1, 4, 1
    v_xor_b32 v5, 1, v5
    v_lshlrev_b32 v147, 13, v5
    v_and_b32 v8, 15, v1
    v_lshlrev_b32 v9, 8, v4
    v_lshl_add_u32 v8, v8, 4, v9
    v_and_b32 v9, 31, v1
    v_add_u32 v10, -20, v9
    v_cmp_gt_u32 vcc, 8, v10
    v_and_b32 v9, 11, v9
    v_min_u32 v9, 1, v9
    v_cndmask_b32 v10, 0, 64, vcc
    v_cmp_eq_u32 vcc, 1, v5
    v_lshl_add_u32 v9, v9, 4, v10
    v_add_u32 v9, 154624, v9
    v_cndmask_b32 v150, v9, v8, vcc
    s_and_b32 s80, s72, 1
    s_lshl_b32 s81, s75, 1
    s_add_u32 s80, s80, s81
    s_lshl_b32 s80, s80, 5
    s_lshl_b32 s81, s76, 2
    s_add_u32 s80, s80, s81
    s_and_b32 s81, s72, 2
    s_add_u32 s80, s80, s81
    s_lshl_b32 s80, s80, 10
    s_add_u32 s97, s80, 262144
    s_lshl_b32 s81, s75, 3
    s_add_u32 s81, s81, s76
    s_lshl_b32 s81, s81, 2
    s_add_u32 s81, s81, s72
    s_lshl_b32 s81, s81, 7
    s_add_u32 s98, s81, 4849664
    s_mov_b32 s90, 0
    s_mov_b32 s96, 0xa
    v_mov_b32 v151, 156672
    s_lshl_b32 s80, s75, 3
    s_lshl_b32 s81, s72, 1
    s_add_u32 s80, s80, s81
    s_lshl_b32 s80, s80, 9
    s_add_u32 s100, s80, 4849664
    s_lshl_b32 s82, s75, 16
    s_lshl_b32 s101, s72, 13
    s_add_u32 s82, s82, s101
    s_add_u32 s79, s82, 262144
    v_and_b32 v8, 7, v1
    v_lshlrev_b32 v184, 7, v8
    v_mov_b32 v48, 0
    v_mov_b32 v49, 0
    v_mov_b32 v50, 0
    v_mov_b32 v51, 0
    v_mov_b32 v52, 0
    v_mov_b32 v53, 0
    v_mov_b32 v54, 0
    v_mov_b32 v55, 0
    v_mov_b32 v56, 0
    v_mov_b32 v57, 0
    v_mov_b32 v58, 0
    v_mov_b32 v59, 0
    v_mov_b32 v60, 0
    v_mov_b32 v61, 0
    v_mov_b32 v62, 0
    v_mov_b32 v63, 0
    v_mov_b32 v64, 0
    v_mov_b32 v65, 0
    v_mov_b32 v66, 0
    v_mov_b32 v67, 0
    v_mov_b32 v68, 0
    v_mov_b32 v69, 0
    v_mov_b32 v70, 0
    v_mov_b32 v71, 0
    v_mov_b32 v72, 0
    v_mov_b32 v73, 0
    v_mov_b32 v74, 0
    v_mov_b32 v75, 0
    v_mov_b32 v76, 0
    v_mov_b32 v77, 0
    v_mov_b32 v78, 0
    v_mov_b32 v79, 0
    v_mov_b32 v140, 0
    v_mov_b32 v141, 0
    v_mov_b32 v142, 0
    v_mov_b32 v143, 0
    v_mov_b32 v145, v2
    v_mov_b32 v146, v150
    s_bitcmp1_b32 s72, 0
    s_cselect_b64 s[32:33], s[18:19], s[16:17]
    s_and_b32 s33, s33, 0xffff
    s_mov_b32 s34, 0x800000
    v_lshlrev_b32 v8, 5, v1
    v_add_u32 v8, s75, v8
    v_sub_u32 v9, 0x800, v8
    v_and_b32 v9, 0x7ff, v9
    v_lshlrev_b32 v10, 6, v1
    v_and_b32 v10, 0x7ff, v10
    s_cmp_eq_u32 s72, 1
    s_cselect_b64 vcc, -1, 0
    v_cndmask_b32 v8, v8, v9, vcc
    s_cmp_ge_u32 s72, 2
    s_cselect_b64 vcc, -1, 0
    v_cndmask_b32 v8, v8, v10, vcc
    v_lshlrev_b32 v187, 12, v8
    s_mov_b32 s80, 0x3eb8aa3b
    s_waitcnt vmcnt(0)
    s_barrier
    ds_read_b64_tr_b16 v[152:153], v149 offset:0
    ds_read_b64_tr_b16 v[154:155], v149 offset:512
    ds_read_b128 v[156:159], v148 offset:0
    ds_read_b64_tr_b16 v[160:161], v149 offset:2048
    ds_read_b64_tr_b16 v[162:163], v149 offset:2560
    ds_read_b128 v[164:167], v148 offset:32
    ds_read_b64_tr_b16 v[168:169], v149 offset:4096
    ds_read_b64_tr_b16 v[170:171], v149 offset:4608
    ds_read_b128 v[172:175], v148 offset:64
    ds_read_b64_tr_b16 v[176:177], v149 offset:6144
    ds_read_b64_tr_b16 v[178:179], v149 offset:6656
    ds_read_b128 v[180:183], v148 offset:96
    s_waitcnt lgkmcnt(9)
    v_mfma_f32_32x32x16_bf16 v[16:31], v[152:155], v[156:159], 0
    ds_read_b64_tr_b16 v[152:153], v149 offset:8192
    ds_read_b64_tr_b16 v[154:155], v149 offset:8704
    ds_read_b128 v[156:159], v148 offset:128
    s_waitcnt lgkmcnt(9)
    v_mfma_f32_32x32x16_bf16 v[16:31], v[160:163], v[164:167], v[16:31]
    ds_read_b64_tr_b16 v[160:161], v149 offset:10240
    ds_read_b64_tr_b16 v[162:163], v149 offset:10752
    ds_read_b128 v[164:167], v148 offset:160
    s_waitcnt lgkmcnt(9)
    v_mfma_f32_32x32x16_bf16 v[16:31], v[168:171], v[172:175], v[16:31]
    ds_read_b64_tr_b16 v[168:169], v149 offset:12288
    ds_read_b64_tr_b16 v[170:171], v149 offset:12800
    ds_read_b128 v[172:175], v148 offset:192
    s_waitcnt lgkmcnt(9)
    v_mfma_f32_32x32x16_bf16 v[16:31], v[176:179], v[180:183], v[16:31]
    ds_read_b64_tr_b16 v[176:177], v149 offset:14336
    ds_read_b64_tr_b16 v[178:179], v149 offset:14848
    ds_read_b128 v[180:183], v148 offset:224
    s_waitcnt lgkmcnt(9)
    v_mfma_f32_32x32x16_bf16 v[16:31], v[152:155], v[156:159], v[16:31]
    ds_read_b64_tr_b16 v[152:153], v149 offset:16384
    ds_read_b64_tr_b16 v[154:155], v149 offset:16896
    ds_read_b128 v[156:159], v148 offset:256
    s_waitcnt lgkmcnt(9)
    v_mfma_f32_32x32x16_bf16 v[16:31], v[160:163], v[164:167], v[16:31]
    ds_read_b64_tr_b16 v[160:161], v149 offset:18432
    ds_read_b64_tr_b16 v[162:163], v149 offset:18944
    ds_read_b128 v[164:167], v148 offset:288
    s_waitcnt lgkmcnt(9)
    v_mfma_f32_32x32x16_bf16 v[16:31], v[168:171], v[172:175], v[16:31]
    ds_read_b64_tr_b16 v[168:169], v149 offset:20480
    ds_read_b64_tr_b16 v[170:171], v149 offset:20992
    ds_read_b128 v[172:175], v148 offset:320
    s_waitcnt lgkmcnt(9)
    v_mfma_f32_32x32x16_bf16 v[16:31], v[176:179], v[180:183], v[16:31]
    ds_read_b64_tr_b16 v[176:177], v149 offset:22528
    ds_read_b64_tr_b16 v[178:179], v149 offset:23040
    ds_read_b128 v[180:183], v148 offset:352
    s_waitcnt lgkmcnt(9)
    v_mfma_f32_32x32x16_bf16 v[16:31], v[152:155], v[156:159], v[16:31]
    ds_read_b64_tr_b16 v[152:153], v149 offset:24576
    ds_read_b64_tr_b16 v[154:155], v149 offset:25088
    ds_read_b128 v[156:159], v148 offset:384
    s_waitcnt lgkmcnt(9)
    v_mfma_f32_32x32x16_bf16 v[16:31], v[160:163], v[164:167], v[16:31]
    ds_read_b64_tr_b16 v[160:161], v149 offset:26624
    ds_read_b64_tr_b16 v[162:163], v149 offset:27136
    ds_read_b128 v[164:167], v148 offset:416
    s_waitcnt lgkmcnt(9)
    v_mfma_f32_32x32x16_bf16 v[16:31], v[168:171], v[172:175], v[16:31]
    ds_read_b64_tr_b16 v[168:169], v149 offset:28672
    ds_read_b64_tr_b16 v[170:171], v149 offset:29184
    ds_read_b128 v[172:175], v148 offset:448
    s_waitcnt lgkmcnt(9)
    v_mfma_f32_32x32x16_bf16 v[16:31], v[176:179], v[180:183], v[16:31]
    ds_read_b64_tr_b16 v[176:177], v149 offset:30720
    ds_read_b64_tr_b16 v[178:179], v149 offset:31232
    ds_read_b128 v[180:183], v148 offset:480
    s_waitcnt lgkmcnt(9)
    v_mfma_f32_32x32x16_bf16 v[16:31], v[152:155], v[156:159], v[16:31]
    ds_read_b64_tr_b16 v[152:153], v149 offset:32768
    ds_read_b64_tr_b16 v[154:155], v149 offset:33280
    ds_read_b128 v[156:159], v148 offset:512
    s_waitcnt lgkmcnt(9)
    v_mfma_f32_32x32x16_bf16 v[16:31], v[160:163], v[164:167], v[16:31]
    ds_read_b64_tr_b16 v[160:161], v149 offset:34816
    ds_read_b64_tr_b16 v[162:163], v149 offset:35328
    ds_read_b128 v[164:167], v148 offset:544
    s_waitcnt lgkmcnt(9)
    v_mfma_f32_32x32x16_bf16 v[16:31], v[168:171], v[172:175], v[16:31]
    ds_read_b64_tr_b16 v[168:169], v149 offset:36864
    ds_read_b64_tr_b16 v[170:171], v149 offset:37376
    ds_read_b128 v[172:175], v148 offset:576
    s_waitcnt lgkmcnt(9)
    v_mfma_f32_32x32x16_bf16 v[16:31], v[176:179], v[180:183], v[16:31]
    ds_read_b64_tr_b16 v[176:177], v149 offset:38912
    ds_read_b64_tr_b16 v[178:179], v149 offset:39424
    ds_read_b128 v[180:183], v148 offset:608
    s_waitcnt lgkmcnt(9)
    v_mfma_f32_32x32x16_bf16 v[16:31], v[152:155], v[156:159], v[16:31]
    ds_read_b64_tr_b16 v[152:153], v149 offset:40960
    ds_read_b64_tr_b16 v[154:155], v149 offset:41472
    ds_read_b128 v[156:159], v148 offset:640
    s_waitcnt lgkmcnt(9)
    v_mfma_f32_32x32x16_bf16 v[16:31], v[160:163], v[164:167], v[16:31]
    ds_read_b64_tr_b16 v[160:161], v149 offset:43008
    ds_read_b64_tr_b16 v[162:163], v149 offset:43520
    ds_read_b128 v[164:167], v148 offset:672
    s_waitcnt lgkmcnt(9)
    v_mfma_f32_32x32x16_bf16 v[16:31], v[168:171], v[172:175], v[16:31]
    ds_read_b64_tr_b16 v[168:169], v149 offset:45056
    ds_read_b64_tr_b16 v[170:171], v149 offset:45568
    ds_read_b128 v[172:175], v148 offset:704
    s_waitcnt lgkmcnt(9)
    v_mfma_f32_32x32x16_bf16 v[16:31], v[176:179], v[180:183], v[16:31]
    ds_read_b64_tr_b16 v[176:177], v149 offset:47104
    ds_read_b64_tr_b16 v[178:179], v149 offset:47616
    ds_read_b128 v[180:183], v148 offset:736
    s_waitcnt lgkmcnt(9)
    v_mfma_f32_32x32x16_bf16 v[16:31], v[152:155], v[156:159], v[16:31]
    ds_read_b64_tr_b16 v[152:153], v149 offset:49152
    ds_read_b64_tr_b16 v[154:155], v149 offset:49664
    ds_read_b128 v[156:159], v148 offset:768
    s_waitcnt lgkmcnt(9)
    v_mfma_f32_32x32x16_bf16 v[16:31], v[160:163], v[164:167], v[16:31]
    ds_read_b64_tr_b16 v[160:161], v149 offset:51200
    ds_read_b64_tr_b16 v[162:163], v149 offset:51712
    ds_read_b128 v[164:167], v148 offset:800
    s_waitcnt lgkmcnt(9)
    v_mfma_f32_32x32x16_bf16 v[16:31], v[168:171], v[172:175], v[16:31]
    ds_read_b64_tr_b16 v[168:169], v149 offset:53248
    ds_read_b64_tr_b16 v[170:171], v149 offset:53760
    ds_read_b128 v[172:175], v148 offset:832
    s_waitcnt lgkmcnt(9)
    v_mfma_f32_32x32x16_bf16 v[16:31], v[176:179], v[180:183], v[16:31]
    ds_read_b64_tr_b16 v[176:177], v149 offset:55296
    ds_read_b64_tr_b16 v[178:179], v149 offset:55808
    ds_read_b128 v[180:183], v148 offset:864
    s_waitcnt lgkmcnt(9)
    v_mfma_f32_32x32x16_bf16 v[16:31], v[152:155], v[156:159], v[16:31]
    ds_read_b64_tr_b16 v[152:153], v149 offset:57344
    ds_read_b64_tr_b16 v[154:155], v149 offset:57856
    ds_read_b128 v[156:159], v148 offset:896
    s_waitcnt lgkmcnt(9)
    v_mfma_f32_32x32x16_bf16 v[16:31], v[160:163], v[164:167], v[16:31]
    ds_read_b64_tr_b16 v[160:161], v149 offset:59392
    ds_read_b64_tr_b16 v[162:163], v149 offset:59904
    ds_read_b128 v[164:167], v148 offset:928
    s_waitcnt lgkmcnt(9)
    v_mfma_f32_32x32x16_bf16 v[16:31], v[168:171], v[172:175], v[16:31]
    ds_read_b64_tr_b16 v[168:169], v149 offset:61440
    ds_read_b64_tr_b16 v[170:171], v149 offset:61952
    ds_read_b128 v[172:175], v148 offset:960
    s_waitcnt lgkmcnt(9)
    v_mfma_f32_32x32x16_bf16 v[16:31], v[176:179], v[180:183], v[16:31]
    ds_read_b64_tr_b16 v[176:177], v149 offset:63488
    ds_read_b64_tr_b16 v[178:179], v149 offset:64000
    ds_read_b128 v[180:183], v148 offset:992
    s_waitcnt lgkmcnt(9)
    v_mfma_f32_32x32x16_bf16 v[16:31], v[152:155], v[156:159], v[16:31]
    s_waitcnt lgkmcnt(6)
    v_mfma_f32_32x32x16_bf16 v[16:31], v[160:163], v[164:167], v[16:31]
    s_waitcnt lgkmcnt(3)
    v_mfma_f32_32x32x16_bf16 v[16:31], v[168:171], v[172:175], v[16:31]
    s_waitcnt lgkmcnt(0)
    v_mfma_f32_32x32x16_bf16 v[16:31], v[176:179], v[180:183], v[16:31]
    s_nop 11
    v_mul_f32 v16, s80, v16
    v_mul_f32 v17, s80, v17
    v_mul_f32 v18, s80, v18
    v_mul_f32 v19, s80, v19
    v_mul_f32 v20, s80, v20
    v_mul_f32 v21, s80, v21
    v_mul_f32 v22, s80, v22
    v_mul_f32 v23, s80, v23
    v_mul_f32 v24, s80, v24
    v_mul_f32 v25, s80, v25
    v_mul_f32 v26, s80, v26
    v_mul_f32 v27, s80, v27
    v_mul_f32 v28, s80, v28
    v_mul_f32 v29, s80, v29
    v_mul_f32 v30, s80, v30
    v_mul_f32 v31, s80, v31
    v_cvt_pk_bf16_f32 v112, v16, v17
    v_cvt_pk_bf16_f32 v113, v18, v19
    v_cvt_pk_bf16_f32 v114, v20, v21
    v_cvt_pk_bf16_f32 v115, v22, v23
    v_cvt_pk_bf16_f32 v116, v24, v25
    v_cvt_pk_bf16_f32 v117, v26, v27
    v_cvt_pk_bf16_f32 v118, v28, v29
    v_cvt_pk_bf16_f32 v119, v30, v31
    s_setprio 1
    s_barrier
    ds_read_b128 v[120:123], v145
    ds_read_b128 v[124:127], v145 offset:2048
    ds_read_b128 v[128:131], v146 offset:1024
    ds_read_b128 v[132:135], v146 offset:1536
    s_waitcnt lgkmcnt(3)
    v_mfma_f32_32x32x16_bf16 v[16:31], v[120:123], v[112:115], 0
    v_mfma_f32_32x32x16_bf16 v[32:47], v[120:123], v[116:119], 0
    s_nop 10
    v_max3_f32 v4, v16, v17, v18
    v_max3_f32 v4, v4, v19, v20
    v_max3_f32 v4, v4, v21, v22
    v_max3_f32 v4, v4, v23, v24
    v_max3_f32 v4, v4, v25, v26
    v_max3_f32 v4, v4, v27, v28
    v_max3_f32 v4, v4, v29, v30
    v_max_f32 v4, v4, v31
    v_max3_f32 v5, v32, v33, v34
    v_max3_f32 v5, v5, v35, v36
    v_max3_f32 v5, v5, v37, v38
    v_max3_f32 v5, v5, v39, v40
    v_max3_f32 v5, v5, v41, v42
    v_max3_f32 v5, v5, v43, v44
    v_max3_f32 v5, v5, v45, v46
    v_max_f32 v5, v5, v47
L_setmax:
    v_mov_b32 v6, v4
    v_mov_b32 v7, v5
    s_mov_b32 s88, 0
    s_nop 0
    v_permlane32_swap_b32 v4, v6
    v_permlane32_swap_b32 v5, v7
    v_max_f32 v4, v4, v6
    v_max_f32 v5, v5, v7
    v_sub_f32 v80, 0xc2cc0000, v4
    v_sub_f32 v81, 0xc2cc0000, v4
    v_sub_f32 v82, 0xc2cc0000, v4
    v_sub_f32 v83, 0xc2cc0000, v4
    v_sub_f32 v84, 0xc2cc0000, v4
    v_sub_f32 v85, 0xc2cc0000, v4
    v_sub_f32 v86, 0xc2cc0000, v4
    v_sub_f32 v87, 0xc2cc0000, v4
    v_sub_f32 v88, 0xc2cc0000, v4
    v_sub_f32 v89, 0xc2cc0000, v4
    v_sub_f32 v90, 0xc2cc0000, v4
    v_sub_f32 v91, 0xc2cc0000, v4
    v_sub_f32 v92, 0xc2cc0000, v4
    v_sub_f32 v93, 0xc2cc0000, v4
    v_sub_f32 v94, 0xc2cc0000, v4
    v_sub_f32 v95, 0xc2cc0000, v4
    v_sub_f32 v96, 0xc2cc0000, v5
    s_waitcnt lgkmcnt(0)
    v_mfma_f32_32x32x16_bf16 v[16:31], v[120:123], v[112:115], v[80:95]
    v_mov_b32 v97, v96
    v_mov_b32 v98, v96
    v_mov_b32 v99, v96
    v_mov_b32 v100, v96
    v_mov_b32 v101, v96
    v_mov_b32 v102, v96
    v_mov_b32 v103, v96
    v_mov_b32 v104, v96
    v_mov_b32 v105, v96
    v_mov_b32 v106, v96
    v_mov_b32 v107, v96
    v_mov_b32 v108, v96
    v_mov_b32 v109, v96
    v_mov_b32 v110, v96
    v_mov_b32 v111, v96
    v_mov_b32 v40, 0
    v_mov_b32 v41, 0
    v_mov_b32 v42, 0
    v_mov_b32 v43, 0
    v_mov_b32 v44, 0
    v_mov_b32 v45, 0
    v_mov_b32 v46, 0
    v_mov_b32 v47, 0
.p2align 6
L_att_loop:
    v_exp_f32 v16, v16
    v_exp_f32 v17, v17
    v_exp_f32 v18, v18
    v_exp_f32 v19, v19
    v_smfmac_f32_32x32x32_bf16 v[64:79], v[140:143], v[40:47], v144
    s_waitcnt lgkmcnt(1)
    v_exp_f32 v20, v20
    v_exp_f32 v21, v21
    v_exp_f32 v22, v22
    v_mfma_f32_32x32x16_bf16 v[32:47], v[120:123], v[116:119], v[96:111]
    ds_read_b128 v[136:139], v146 offset:3072
    v_exp_f32 v23, v23
    v_exp_f32 v24, v24
    v_exp_f32 v25, v25
    v_smfmac_f32_32x32x32_bf16 v[48:63], v[128:131], v[16:23], v144
    ds_read_b128 v[140:143], v146 offset:3584
    v_exp_f32 v26, v26
    v_exp_f32 v27, v27
    v_exp_f32 v28, v28
    v_exp_f32 v29, v29
    v_exp_f32 v30, v30
    v_exp_f32 v31, v31
    v_exp_f32 v32, v32
    v_exp_f32 v33, v33
    v_exp_f32 v34, v34
    v_exp_f32 v35, v35
    v_smfmac_f32_32x32x32_bf16 v[48:63], v[132:135], v[24:31], v144
    s_waitcnt lgkmcnt(2)
    v_exp_f32 v36, v36
    v_exp_f32 v37, v37
    v_exp_f32 v38, v38
    v_mfma_f32_32x32x16_bf16 v[16:31], v[124:127], v[112:115], v[80:95]
    ds_read_b128 v[120:123], v145 offset:4096
    v_exp_f32 v39, v39
    v_exp_f32 v40, v40
    v_exp_f32 v41, v41
    v_smfmac_f32_32x32x32_bf16 v[64:79], v[128:131], v[32:39], v144
    s_nop 0
    v_exp_f32 v42, v42
    v_exp_f32 v43, v43
    v_exp_f32 v44, v44
    v_exp_f32 v45, v45
    v_exp_f32 v46, v46
    v_exp_f32 v47, v47
    v_exp_f32 v16, v16
    v_exp_f32 v17, v17
    v_exp_f32 v18, v18
    v_exp_f32 v19, v19
    v_smfmac_f32_32x32x32_bf16 v[64:79], v[132:135], v[40:47], v144
    s_waitcnt lgkmcnt(1)
    v_exp_f32 v20, v20
    v_exp_f32 v21, v21
    v_exp_f32 v22, v22
    v_mfma_f32_32x32x16_bf16 v[32:47], v[124:127], v[116:119], v[96:111]
    ds_read_b128 v[128:131], v146 offset:5120
    v_exp_f32 v23, v23
    v_exp_f32 v24, v24
    v_exp_f32 v25, v25
    v_smfmac_f32_32x32x32_bf16 v[48:63], v[136:139], v[16:23], v144
    ds_read_b128 v[132:135], v146 offset:5632
    v_exp_f32 v26, v26
    v_exp_f32 v27, v27
    v_exp_f32 v28, v28
    v_exp_f32 v29, v29
    v_exp_f32 v30, v30
    v_exp_f32 v31, v31
    v_exp_f32 v32, v32
    v_exp_f32 v33, v33
    v_exp_f32 v34, v34
    v_exp_f32 v35, v35
    v_smfmac_f32_32x32x32_bf16 v[48:63], v[140:143], v[24:31], v144
    s_waitcnt lgkmcnt(2)
    v_exp_f32 v36, v36
    v_exp_f32 v37, v37
    v_exp_f32 v38, v38
    v_mfma_f32_32x32x16_bf16 v[16:31], v[120:123], v[112:115], v[80:95]
    ds_read_b128 v[124:127], v145 offset:6144
    v_exp_f32 v39, v39
    v_exp_f32 v40, v40
    v_exp_f32 v41, v41
    v_smfmac_f32_32x32x32_bf16 v[64:79], v[136:139], v[32:39], v144
    s_bitcmp1_b32 s96, s88
    s_cbranch_scc1 L_sync
L_nobar:
    v_add_u32 v145, 0x2000, v145
    v_exp_f32 v42, v42
    v_exp_f32 v43, v43
    v_exp_f32 v44, v44
    v_exp_f32 v45, v45
    v_exp_f32 v46, v46
    v_exp_f32 v47, v47
    v_exp_f32 v16, v16
    v_exp_f32 v17, v17
    v_exp_f32 v18, v18
    v_exp_f32 v19, v19
    v_smfmac_f32_32x32x32_bf16 v[64:79], v[140:143], v[40:47], v144
    s_waitcnt lgkmcnt(1)
    v_exp_f32 v20, v20
    v_exp_f32 v21, v21
    v_exp_f32 v22, v22
    v_mfma_f32_32x32x16_bf16 v[32:47], v[120:123], v[116:119], v[96:111]
    ds_read_b128 v[136:139], v146 offset:7168
    v_exp_f32 v23, v23
    v_exp_f32 v24, v24
    v_exp_f32 v25, v25
    v_smfmac_f32_32x32x32_bf16 v[48:63], v[128:131], v[16:23], v144
    ds_read_b128 v[140:143], v146 offset:7680
    v_exp_f32 v26, v26
    v_exp_f32 v27, v27
    v_exp_f32 v28, v28
    v_exp_f32 v29, v29
    v_exp_f32 v30, v30
    v_exp_f32 v31, v31
    v_exp_f32 v32, v32
    v_exp_f32 v33, v33
    v_exp_f32 v34, v34
    v_exp_f32 v35, v35
    v_smfmac_f32_32x32x32_bf16 v[48:63], v[132:135], v[24:31], v144
    s_waitcnt lgkmcnt(2)
    v_exp_f32 v36, v36
    v_exp_f32 v37, v37
    v_exp_f32 v38, v38
    v_mfma_f32_32x32x16_bf16 v[16:31], v[124:127], v[112:115], v[80:95]
    ds_read_b128 v[120:123], v145 offset:0
    v_exp_f32 v39, v39
    v_exp_f32 v40, v40
    v_exp_f32 v41, v41
    v_smfmac_f32_32x32x32_bf16 v[64:79], v[128:131], v[32:39], v144
    v_add_u32 v146, v147, v146
    v_exp_f32 v42, v42
    v_exp_f32 v43, v43
    v_exp_f32 v44, v44
    v_exp_f32 v45, v45
    v_exp_f32 v46, v46
    v_exp_f32 v47, v47
    v_exp_f32 v16, v16
    v_exp_f32 v17, v17
    v_exp_f32 v18, v18
    v_exp_f32 v19, v19
    v_smfmac_f32_32x32x32_bf16 v[64:79], v[132:135], v[40:47], v144
    s_waitcnt lgkmcnt(1)
    v_exp_f32 v20, v20
    v_exp_f32 v21, v21
    v_exp_f32 v22, v22
    v_mfma_f32_32x32x16_bf16 v[32:47], v[124:127], v[116:119], v[96:111]
    ds_read_b128 v[128:131], v146 offset:1024
    v_exp_f32 v23, v23
    v_exp_f32 v24, v24
    v_exp_f32 v25, v25
    v_smfmac_f32_32x32x32_bf16 v[48:63], v[136:139], v[16:23], v144
    ds_read_b128 v[132:135], v146 offset:1536
    v_exp_f32 v26, v26
    v_exp_f32 v27, v27
    v_exp_f32 v28, v28
    v_exp_f32 v29, v29
    v_exp_f32 v30, v30
    v_exp_f32 v31, v31
    v_exp_f32 v32, v32
    v_exp_f32 v33, v33
    v_exp_f32 v34, v34
    v_exp_f32 v35, v35
    v_smfmac_f32_32x32x32_bf16 v[48:63], v[140:143], v[24:31], v144
    s_waitcnt lgkmcnt(2)
    v_exp_f32 v36, v36
    v_exp_f32 v37, v37
    v_exp_f32 v38, v38
    v_mfma_f32_32x32x16_bf16 v[16:31], v[120:123], v[112:115], v[80:95]
    ds_read_b128 v[124:127], v145 offset:2048
    v_exp_f32 v39, v39
    v_exp_f32 v40, v40
    v_exp_f32 v41, v41
    v_smfmac_f32_32x32x32_bf16 v[64:79], v[136:139], v[32:39], v144
    s_add_u32 s88, s88, 1
    s_cmp_lt_u32 s88, 16
    v_exp_f32 v42, v42
    v_exp_f32 v43, v43
    v_exp_f32 v44, v44
    v_exp_f32 v45, v45
    v_exp_f32 v46, v46
    v_exp_f32 v47, v47
    s_cbranch_scc1 L_att_loop
    s_mov_b32 s80, 0x71800000
    v_rcp_f32 v4, v56
    v_smfmac_f32_32x32x32_bf16 v[64:79], v[140:143], v[40:47], v144
    ds_read_b32 v7, v151 offset:28
    ds_read_b64 v[8:9], v151 offset:16
    v_cmp_nle_f32_e64 vcc, v56, s80
    v_mul_f32 v16, v4, v48
    v_mul_f32 v17, v4, v49
    v_mul_f32 v18, v4, v50
    v_mul_f32 v19, v4, v51
    v_mul_f32 v20, v4, v52
    v_mul_f32 v21, v4, v53
    v_mul_f32 v22, v4, v54
    v_mul_f32 v23, v4, v55
    v_cvt_pk_bf16_f32 v16, v16, v17
    v_cvt_pk_bf16_f32 v17, v18, v19
    v_cvt_pk_bf16_f32 v18, v20, v21
    v_cvt_pk_bf16_f32 v19, v22, v23
    s_waitcnt lgkmcnt(0)
    v_readfirstlane_b32 s99, v7
    v_rcp_f32 v5, v72
    v_cmp_nle_f32_e64 s[92:93], v72, s80
    s_cmp_eq_u32 s99, 0
    s_cbranch_scc1 L_ostA_wt
    buffer_store_dwordx4 v[16:19], v2, s[44:47], s97 offen
L_ostA_done:
    v_mul_f32 v32, v5, v64
    v_mul_f32 v33, v5, v65
    v_mul_f32 v34, v5, v66
    v_mul_f32 v35, v5, v67
    v_mul_f32 v36, v5, v68
    v_mul_f32 v37, v5, v69
    v_mul_f32 v38, v5, v70
    v_mul_f32 v39, v5, v71
    s_or_b64 vcc, vcc, s[92:93]
    v_cvt_pk_bf16_f32 v20, v32, v33
    v_cvt_pk_bf16_f32 v21, v34, v35
    v_cvt_pk_bf16_f32 v22, v36, v37
    v_cvt_pk_bf16_f32 v23, v38, v39
    s_cmp_eq_u64 vcc, 0
    s_cbranch_scc0 L_fallback
L_att_done:
    s_cmp_eq_u32 s99, 0
    s_cbranch_scc1 L_ost_wt
    buffer_store_dwordx4 v[20:23], v2, s[44:47], s97 offen offset:1024
    v_readfirstlane_b32 s86, v8
    v_readfirstlane_b32 s87, v9
    s_mov_b64 exec, 1
    s_waitcnt vmcnt(0)
    buffer_store_dwordx2 v[8:9], off, s[44:47], s98
L_ost_done:
    s_mov_b64 exec, -1
    s_barrier
    s_mov_b32 s91, 400000
L_pollO:
    buffer_load_dwordx2 v[10:11], v184, s[44:47], s100 offen sc1
    s_sub_u32 s91, s91, 1
    s_cmp_eq_u32 s91, 0
    s_cbranch_scc1 L_pollO_done
    s_waitcnt vmcnt(0)
    v_cmp_ne_u64 vcc, s[86:87], v[10:11]
    s_nop 0
    s_cmp_eq_u64 vcc, 0
    s_cbranch_scc0 L_pollO
L_pollO_done:
    s_waitcnt vmcnt(0)
    s_add_u32 m0, s101, 0
    s_add_u32 s81, s79, 0
    buffer_load_dwordx4 v2, s[44:47], s81 offen offset:0 sc1 lds
    buffer_load_dwordx4 v2, s[44:47], s81 offen offset:1024 sc1 lds
    s_add_u32 m0, s101, 32768
    s_add_u32 s81, s79, 32768
    buffer_load_dwordx4 v2, s[44:47], s81 offen offset:0 sc1 lds
    buffer_load_dwordx4 v2, s[44:47], s81 offen offset:1024 sc1 lds
    s_add_u32 m0, s101, 2048
    s_add_u32 s81, s79, 2048
    buffer_load_dwordx4 v2, s[44:47], s81 offen offset:0 sc1 lds
    buffer_load_dwordx4 v2, s[44:47], s81 offen offset:1024 sc1 lds
    s_add_u32 m0, s101, 34816
    s_add_u32 s81, s79, 34816
    buffer_load_dwordx4 v2, s[44:47], s81 offen offset:0 sc1 lds
    buffer_load_dwordx4 v2, s[44:47], s81 offen offset:1024 sc1 lds
    s_add_u32 m0, s101, 4096
    s_add_u32 s81, s79, 4096
    buffer_load_dwordx4 v2, s[44:47], s81 offen offset:0 sc1 lds
    buffer_load_dwordx4 v2, s[44:47], s81 offen offset:1024 sc1 lds
    s_add_u32 m0, s101, 36864
    s_add_u32 s81, s79, 36864
    buffer_load_dwordx4 v2, s[44:47], s81 offen offset:0 sc1 lds
    buffer_load_dwordx4 v2, s[44:47], s81 offen offset:1024 sc1 lds
    s_add_u32 m0, s101, 6144
    s_add_u32 s81, s79, 6144
    buffer_load_dwordx4 v2, s[44:47], s81 offen offset:0 sc1 lds
    buffer_load_dwordx4 v2, s[44:47], s81 offen offset:1024 sc1 lds
    s_add_u32 m0, s101, 38912
    s_add_u32 s81, s79, 38912
    buffer_load_dwordx4 v2, s[44:47], s81 offen offset:0 sc1 lds
    buffer_load_dwordx4 v2, s[44:47], s81 offen offset:1024 sc1 lds
    s_waitcnt vmcnt(12)
    s_barrier
    s_waitcnt vmcnt(8)
    s_barrier
    s_waitcnt vmcnt(4)
    s_barrier
    s_waitcnt vmcnt(0)
    s_barrier
    s_endpgm
L_ostA_wt:
    buffer_store_dwordx4 v[16:19], v2, s[44:47], s97 offen sc1
    s_branch L_ostA_done
L_ost_wt:
    buffer_store_dwordx4 v[20:23], v2, s[44:47], s97 offen offset:1024 sc1
    v_readfirstlane_b32 s86, v8
    v_readfirstlane_b32 s87, v9
    s_mov_b64 exec, 1
    s_waitcnt vmcnt(0)
    buffer_store_dwordx2 v[8:9], off, s[44:47], s98 sc1
    s_branch L_ost_done
L_sync:
    s_cmp_eq_u32 s88, 1
    s_cbranch_scc0 L_sync3
    s_mov_b32 s91, 3200000
    v_mov_b32 v4, 156716
L_wg1:
    ds_read_b32 v5, v4
    s_sub_u32 s91, s91, 1
    s_cmp_eq_u32 s91, 0
    s_cbranch_scc1 L_wg1_done
    s_waitcnt lgkmcnt(0)
    v_readfirstlane_b32 s84, v5
    s_nop 0
    s_cmp_ge_u32 s84, 4
    s_cbranch_scc0 L_wg1
L_wg1_done:
    s_waitcnt lgkmcnt(0)
    s_branch L_nobar
L_sync3:
    buffer_load_dword v185, v187, s[32:35], 0 offen
    s_mov_b32 s91, 3200000
    v_mov_b32 v4, 156720
L_wkvl:
    ds_read_b32 v5, v4
    s_sub_u32 s91, s91, 1
    s_cmp_eq_u32 s91, 0
    s_cbranch_scc1 L_wkvl_done
    s_waitcnt lgkmcnt(0)
    v_readfirstlane_b32 s84, v5
    s_nop 0
    s_cmp_ge_u32 s84, 4
    s_cbranch_scc0 L_wkvl
L_wkvl_done:
    s_waitcnt lgkmcnt(0)
    s_mov_b32 s83, 120
    v_frexp_exp_i32_f32 v12, v56
    v_add_u32 v12, 37, v12
    v_med3_i32 v12, v12, 0, s83
    v_cvt_f32_i32 v6, v12
    v_sub_u32 v12, 0, v12
    v_ldexp_f32 v8, 1.0, v12
    v_pk_mul_f32 v[48:49], v[48:49], v[8:9] op_sel_hi:[1,0]
    v_pk_mul_f32 v[50:51], v[50:51], v[8:9] op_sel_hi:[1,0]
    v_pk_mul_f32 v[52:53], v[52:53], v[8:9] op_sel_hi:[1,0]
    v_pk_mul_f32 v[54:55], v[54:55], v[8:9] op_sel_hi:[1,0]
    v_pk_mul_f32 v[56:57], v[56:57], v[8:9] op_sel_hi:[1,0]
    s_nop 0
    v_frexp_exp_i32_f32 v13, v72
    v_add_u32 v13, 37, v13
    v_med3_i32 v13, v13, 0, s83
    v_cvt_f32_i32 v10, v13
    v_sub_u32 v13, 0, v13
    v_ldexp_f32 v14, 1.0, v13
    v_pk_mul_f32 v[64:65], v[64:65], v[14:15] op_sel_hi:[1,0]
    v_pk_mul_f32 v[66:67], v[66:67], v[14:15] op_sel_hi:[1,0]
    v_pk_mul_f32 v[68:69], v[68:69], v[14:15] op_sel_hi:[1,0]
    v_pk_mul_f32 v[70:71], v[70:71], v[14:15] op_sel_hi:[1,0]
    v_pk_mul_f32 v[72:73], v[72:73], v[14:15] op_sel_hi:[1,0]
    v_pk_mul_f32 v[40:41], v[40:41], v[14:15] op_sel_hi:[1,0]
    v_pk_add_f32 v[42:43], v[42:43], v[10:11] op_sel_hi:[1,0] neg_lo:[0,1] neg_hi:[0,1]
    v_pk_add_f32 v[44:45], v[44:45], v[10:11] op_sel_hi:[1,0] neg_lo:[0,1] neg_hi:[0,1]
    v_pk_add_f32 v[46:47], v[46:47], v[10:11] op_sel_hi:[1,0] neg_lo:[0,1] neg_hi:[0,1]
    v_pk_add_f32 v[16:17], v[16:17], v[6:7] op_sel_hi:[1,0] neg_lo:[0,1] neg_hi:[0,1]
    v_pk_add_f32 v[18:19], v[18:19], v[6:7] op_sel_hi:[1,0] neg_lo:[0,1] neg_hi:[0,1]
    v_pk_add_f32 v[20:21], v[20:21], v[6:7] op_sel_hi:[1,0] neg_lo:[0,1] neg_hi:[0,1]
    v_pk_add_f32 v[22:23], v[22:23], v[6:7] op_sel_hi:[1,0] neg_lo:[0,1] neg_hi:[0,1]
    v_pk_add_f32 v[24:25], v[24:25], v[6:7] op_sel_hi:[1,0] neg_lo:[0,1] neg_hi:[0,1]
    v_pk_add_f32 v[26:27], v[26:27], v[6:7] op_sel_hi:[1,0] neg_lo:[0,1] neg_hi:[0,1]
    v_pk_add_f32 v[28:29], v[28:29], v[6:7] op_sel_hi:[1,0] neg_lo:[0,1] neg_hi:[0,1]
    v_pk_add_f32 v[30:31], v[30:31], v[6:7] op_sel_hi:[1,0] neg_lo:[0,1] neg_hi:[0,1]
    v_pk_add_f32 v[80:81], v[80:81], v[6:7] op_sel_hi:[1,0] neg_lo:[0,1] neg_hi:[0,1]
    v_pk_add_f32 v[82:83], v[82:83], v[6:7] op_sel_hi:[1,0] neg_lo:[0,1] neg_hi:[0,1]
    v_pk_add_f32 v[84:85], v[84:85], v[6:7] op_sel_hi:[1,0] neg_lo:[0,1] neg_hi:[0,1]
    v_pk_add_f32 v[86:87], v[86:87], v[6:7] op_sel_hi:[1,0] neg_lo:[0,1] neg_hi:[0,1]
    v_pk_add_f32 v[88:89], v[88:89], v[6:7] op_sel_hi:[1,0] neg_lo:[0,1] neg_hi:[0,1]
    v_pk_add_f32 v[90:91], v[90:91], v[6:7] op_sel_hi:[1,0] neg_lo:[0,1] neg_hi:[0,1]
    v_pk_add_f32 v[92:93], v[92:93], v[6:7] op_sel_hi:[1,0] neg_lo:[0,1] neg_hi:[0,1]
    v_pk_add_f32 v[94:95], v[94:95], v[6:7] op_sel_hi:[1,0] neg_lo:[0,1] neg_hi:[0,1]
    v_pk_add_f32 v[96:97], v[96:97], v[10:11] op_sel_hi:[1,0] neg_lo:[0,1] neg_hi:[0,1]
    v_pk_add_f32 v[98:99], v[98:99], v[10:11] op_sel_hi:[1,0] neg_lo:[0,1] neg_hi:[0,1]
    v_pk_add_f32 v[100:101], v[100:101], v[10:11] op_sel_hi:[1,0] neg_lo:[0,1] neg_hi:[0,1]
    v_pk_add_f32 v[102:103], v[102:103], v[10:11] op_sel_hi:[1,0] neg_lo:[0,1] neg_hi:[0,1]
    v_pk_add_f32 v[104:105], v[104:105], v[10:11] op_sel_hi:[1,0] neg_lo:[0,1] neg_hi:[0,1]
    v_pk_add_f32 v[106:107], v[106:107], v[10:11] op_sel_hi:[1,0] neg_lo:[0,1] neg_hi:[0,1]
    v_pk_add_f32 v[108:109], v[108:109], v[10:11] op_sel_hi:[1,0] neg_lo:[0,1] neg_hi:[0,1]
    v_pk_add_f32 v[110:111], v[110:111], v[10:11] op_sel_hi:[1,0] neg_lo:[0,1] neg_hi:[0,1]
    s_branch L_nobar
L_fallback:
    s_cmp_eq_u32 s90, 0
    s_cbranch_scc0 L_att_done
    s_mov_b32 s90, 1
    s_mov_b32 s96, 0
    v_mov_b32 v4, 0xff800000
    v_mov_b32 v5, 0xff800000
    v_mov_b32 v145, v2
    s_mov_b32 s88, 0
L_fb_loop:
    ds_read_b128 v[120:123], v145
    s_waitcnt lgkmcnt(0)
    v_mfma_f32_32x32x16_bf16 v[16:31], v[120:123], v[112:115], 0
    v_mfma_f32_32x32x16_bf16 v[32:47], v[120:123], v[116:119], 0
    v_add_u32 v145, 0x800, v145
    s_nop 10
    v_max3_f32 v4, v4, v16, v17
    v_max3_f32 v4, v4, v18, v19
    v_max3_f32 v4, v4, v20, v21
    v_max3_f32 v4, v4, v22, v23
    v_max3_f32 v4, v4, v24, v25
    v_max3_f32 v4, v4, v26, v27
    v_max3_f32 v4, v4, v28, v29
    v_max3_f32 v4, v4, v30, v31
    v_max3_f32 v5, v5, v32, v33
    v_max3_f32 v5, v5, v34, v35
    v_max3_f32 v5, v5, v36, v37
    v_max3_f32 v5, v5, v38, v39
    v_max3_f32 v5, v5, v40, v41
    v_max3_f32 v5, v5, v42, v43
    v_max3_f32 v5, v5, v44, v45
    v_max3_f32 v5, v5, v46, v47
    s_add_u32 s88, s88, 1
    s_cmp_lt_u32 s88, 64
    s_cbranch_scc1 L_fb_loop
    v_mov_b32 v145, v2
    v_mov_b32 v146, v150
    v_mov_b32 v48, 0
    v_mov_b32 v49, 0
    v_mov_b32 v50, 0
    v_mov_b32 v51, 0
    v_mov_b32 v52, 0
    v_mov_b32 v53, 0
    v_mov_b32 v54, 0
    v_mov_b32 v55, 0
    v_mov_b32 v56, 0
    v_mov_b32 v57, 0
    v_mov_b32 v58, 0
    v_mov_b32 v59, 0
    v_mov_b32 v60, 0
    v_mov_b32 v61, 0
    v_mov_b32 v62, 0
    v_mov_b32 v63, 0
    v_mov_b32 v64, 0
    v_mov_b32 v65, 0
    v_mov_b32 v66, 0
    v_mov_b32 v67, 0
    v_mov_b32 v68, 0
    v_mov_b32 v69, 0
    v_mov_b32 v70, 0
    v_mov_b32 v71, 0
    v_mov_b32 v72, 0
    v_mov_b32 v73, 0
    v_mov_b32 v74, 0
    v_mov_b32 v75, 0
    v_mov_b32 v76, 0
    v_mov_b32 v77, 0
    v_mov_b32 v78, 0
    v_mov_b32 v79, 0
    v_mov_b32 v140, 0
    v_mov_b32 v141, 0
    v_mov_b32 v142, 0
    v_mov_b32 v143, 0
    ds_read_b128 v[120:123], v145
    ds_read_b128 v[124:127], v145 offset:2048
    ds_read_b128 v[128:131], v146 offset:1024
    ds_read_b128 v[132:135], v146 offset:1536
    s_branch L_setmax
L_aux:
    v_mov_b32 v222, 156704
    v_mov_b32 v223, 1
    s_cmp_eq_u32 s78, 0
    s_cbranch_scc0 L_np
    v_and_b32 v211, 15, v1
    v_lshrrev_b32 v212, 4, v1
    s_lshl_b32 s80, s77, 4
    v_add_u32 v213, s80, v211
    v_mul_u32_u24 v213, 1040, v213
    v_lshl_add_u32 v213, v212, 4, v213
    v_add_u32 v213, 16384, v213
    v_bfe_u32 v214, v1, 2, 2
    v_lshl_add_u32 v214, v212, 3, v214
    v_lshlrev_b32 v214, 5, v214
    v_and_b32 v215, 3, v1
    s_and_b32 s83, s77, 1
    s_lshr_b32 s80, s77, 1
    s_lshl_b32 s82, s75, 1
    s_add_u32 s82, s82, s80
    s_lshl_b32 s81, s82, 1
    s_and_b32 s80, s76, 1
    s_add_u32 s81, s81, s80
    s_lshl_b32 s81, s81, 1
    s_add_u32 s81, s81, s83
    s_lshl_b32 s81, s81, 7
    s_add_u32 s97, s81, 4718592
    s_lshl_b32 s96, s82, 11
    v_and_b32 v217, 1, v212
    v_lshlrev_b32 v217, 3, v217
    v_lshl_add_u32 v217, v211, 4, v217
    v_lshrrev_b32 v216, 1, v212
    s_mov_b32 s85, 0
    v_and_b32 v220, 15, v1
    v_lshlrev_b32 v220, 7, v220
    buffer_load_dword v201, v220, s[44:47], s96 offen sc1
    buffer_load_dword v202, off, s[44:47], s97 sc1
    s_bitcmp1_b32 s76, 0
    s_cbranch_scc1 L_prodV
    v_lshl_add_u32 v214, v215, 3, v214
    v_lshl_add_u32 v216, v216, 9, v217
    s_lshl_b32 s81, s83, 8
    s_add_u32 s96, s96, s81
    s_waitcnt vmcnt(2)
    s_mov_b64 exec, 1
    ds_add_u32 v222, v223
    s_mov_b64 exec, -1
    s_mov_b32 s91, 3200000
    v_mov_b32 v218, 156704
L_chK_w:
    ds_read_b32 v219, v218
    s_sub_u32 s91, s91, 1
    s_cmp_eq_u32 s91, 0
    s_cbranch_scc1 L_chK_w_done
    s_waitcnt lgkmcnt(0)
    v_readfirstlane_b32 s84, v219
    s_nop 0
    s_cmp_ge_u32 s84, 4
    s_cbranch_scc1 L_chK_w_done
    s_sleep 1
    s_branch L_chK_w
L_chK_w_done:
    s_waitcnt lgkmcnt(0)
L_chK:
    ds_read_b64_tr_b16 v[16:17], v214 offset:0
    ds_read_b64_tr_b16 v[18:19], v214 offset:128
    ds_read_b128 v[20:23], v213 offset:0
    ds_read_b64_tr_b16 v[24:25], v214 offset:1024
    ds_read_b64_tr_b16 v[26:27], v214 offset:1152
    ds_read_b128 v[28:31], v213 offset:64
    ds_read_b64_tr_b16 v[32:33], v214 offset:2048
    ds_read_b64_tr_b16 v[34:35], v214 offset:2176
    ds_read_b128 v[36:39], v213 offset:128
    ds_read_b64_tr_b16 v[40:41], v214 offset:3072
    ds_read_b64_tr_b16 v[42:43], v214 offset:3200
    ds_read_b128 v[44:47], v213 offset:192
    s_waitcnt lgkmcnt(9)
    v_mfma_f32_16x16x32_bf16 v[192:195], v[16:19], v[20:23], 0
    ds_read_b64_tr_b16 v[48:49], v214 offset:4096
    ds_read_b64_tr_b16 v[50:51], v214 offset:4224
    ds_read_b128 v[52:55], v213 offset:256
    s_waitcnt lgkmcnt(9)
    v_mfma_f32_16x16x32_bf16 v[192:195], v[24:27], v[28:31], v[192:195]
    ds_read_b64_tr_b16 v[56:57], v214 offset:5120
    ds_read_b64_tr_b16 v[58:59], v214 offset:5248
    ds_read_b128 v[60:63], v213 offset:320
    s_waitcnt lgkmcnt(9)
    v_mfma_f32_16x16x32_bf16 v[192:195], v[32:35], v[36:39], v[192:195]
    ds_read_b64_tr_b16 v[64:65], v214 offset:6144
    ds_read_b64_tr_b16 v[66:67], v214 offset:6272
    ds_read_b128 v[68:71], v213 offset:384
    s_waitcnt lgkmcnt(9)
    v_mfma_f32_16x16x32_bf16 v[192:195], v[40:43], v[44:47], v[192:195]
    ds_read_b64_tr_b16 v[72:73], v214 offset:7168
    ds_read_b64_tr_b16 v[74:75], v214 offset:7296
    ds_read_b128 v[76:79], v213 offset:448
    s_waitcnt lgkmcnt(9)
    v_mfma_f32_16x16x32_bf16 v[192:195], v[48:51], v[52:55], v[192:195]
    ds_read_b64_tr_b16 v[80:81], v214 offset:8192
    ds_read_b64_tr_b16 v[82:83], v214 offset:8320
    ds_read_b128 v[84:87], v213 offset:512
    s_waitcnt lgkmcnt(9)
    v_mfma_f32_16x16x32_bf16 v[192:195], v[56:59], v[60:63], v[192:195]
    ds_read_b64_tr_b16 v[88:89], v214 offset:9216
    ds_read_b64_tr_b16 v[90:91], v214 offset:9344
    ds_read_b128 v[92:95], v213 offset:576
    s_waitcnt lgkmcnt(9)
    v_mfma_f32_16x16x32_bf16 v[192:195], v[64:67], v[68:71], v[192:195]
    ds_read_b64_tr_b16 v[96:97], v214 offset:10240
    ds_read_b64_tr_b16 v[98:99], v214 offset:10368
    ds_read_b128 v[100:103], v213 offset:640
    s_waitcnt lgkmcnt(9)
    v_mfma_f32_16x16x32_bf16 v[192:195], v[72:75], v[76:79], v[192:195]
    ds_read_b64_tr_b16 v[104:105], v214 offset:11264
    ds_read_b64_tr_b16 v[106:107], v214 offset:11392
    ds_read_b128 v[108:111], v213 offset:704
    s_waitcnt lgkmcnt(9)
    v_mfma_f32_16x16x32_bf16 v[192:195], v[80:83], v[84:87], v[192:195]
    ds_read_b64_tr_b16 v[112:113], v214 offset:12288
    ds_read_b64_tr_b16 v[114:115], v214 offset:12416
    ds_read_b128 v[116:119], v213 offset:768
    s_waitcnt lgkmcnt(9)
    v_mfma_f32_16x16x32_bf16 v[192:195], v[88:91], v[92:95], v[192:195]
    ds_read_b64_tr_b16 v[120:121], v214 offset:13312
    ds_read_b64_tr_b16 v[122:123], v214 offset:13440
    ds_read_b128 v[124:127], v213 offset:832
    s_waitcnt lgkmcnt(9)
    v_mfma_f32_16x16x32_bf16 v[192:195], v[96:99], v[100:103], v[192:195]
    ds_read_b64_tr_b16 v[128:129], v214 offset:14336
    ds_read_b64_tr_b16 v[130:131], v214 offset:14464
    ds_read_b128 v[132:135], v213 offset:896
    s_waitcnt lgkmcnt(9)
    v_mfma_f32_16x16x32_bf16 v[192:195], v[104:107], v[108:111], v[192:195]
    ds_read_b64_tr_b16 v[136:137], v214 offset:15360
    ds_read_b64_tr_b16 v[138:139], v214 offset:15488
    ds_read_b128 v[140:143], v213 offset:960
    s_waitcnt lgkmcnt(9)
    v_mfma_f32_16x16x32_bf16 v[192:195], v[112:115], v[116:119], v[192:195]
    s_waitcnt lgkmcnt(6)
    v_mfma_f32_16x16x32_bf16 v[192:195], v[120:123], v[124:127], v[192:195]
    s_waitcnt lgkmcnt(3)
    v_mfma_f32_16x16x32_bf16 v[192:195], v[128:131], v[132:135], v[192:195]
    s_waitcnt lgkmcnt(0)
    v_mfma_f32_16x16x32_bf16 v[192:195], v[136:139], v[140:143], v[192:195]
    s_nop 7
    s_branch L_prodS
L_prodV:
    v_lshl_add_u32 v216, v216, 8, v217
    v_and_b32 v217, 1, v215
    v_lshl_add_u32 v214, v217, 4, v214
    v_lshrrev_b32 v217, 1, v215
    v_lshl_add_u32 v214, v217, 3, v214
    s_lshl_b32 s81, s83, 9
    s_add_u32 s96, s96, s81
    s_add_u32 s96, s96, 1024
    s_waitcnt vmcnt(2)
    s_mov_b64 exec, 1
    ds_add_u32 v222, v223
    s_mov_b64 exec, -1
    s_mov_b32 s91, 3200000
    v_mov_b32 v218, 156704
L_chV_w:
    ds_read_b32 v219, v218
    s_sub_u32 s91, s91, 1
    s_cmp_eq_u32 s91, 0
    s_cbranch_scc1 L_chV_w_done
    s_waitcnt lgkmcnt(0)
    v_readfirstlane_b32 s84, v219
    s_nop 0
    s_cmp_ge_u32 s84, 4
    s_cbranch_scc1 L_chV_w_done
    s_sleep 1
    s_branch L_chV_w
L_chV_w_done:
    s_waitcnt lgkmcnt(0)
L_chV:
    ds_read_b64_tr_b16 v[16:17], v214 offset:0
    ds_read_b64_tr_b16 v[18:19], v214 offset:128
    ds_read_b128 v[20:23], v213 offset:0
    ds_read_b64_tr_b16 v[24:25], v214 offset:1024
    ds_read_b64_tr_b16 v[26:27], v214 offset:1152
    ds_read_b128 v[28:31], v213 offset:64
    ds_read_b64_tr_b16 v[32:33], v214 offset:2048
    ds_read_b64_tr_b16 v[34:35], v214 offset:2176
    ds_read_b128 v[36:39], v213 offset:128
    ds_read_b64_tr_b16 v[40:41], v214 offset:3072
    ds_read_b64_tr_b16 v[42:43], v214 offset:3200
    ds_read_b128 v[44:47], v213 offset:192
    s_waitcnt lgkmcnt(9)
    v_mfma_f32_16x16x32_bf16 v[192:195], v[20:23], v[16:19], 0
    ds_read_b64_tr_b16 v[48:49], v214 offset:4096
    ds_read_b64_tr_b16 v[50:51], v214 offset:4224
    ds_read_b128 v[52:55], v213 offset:256
    s_waitcnt lgkmcnt(9)
    v_mfma_f32_16x16x32_bf16 v[192:195], v[28:31], v[24:27], v[192:195]
    ds_read_b64_tr_b16 v[56:57], v214 offset:5120
    ds_read_b64_tr_b16 v[58:59], v214 offset:5248
    ds_read_b128 v[60:63], v213 offset:320
    s_waitcnt lgkmcnt(9)
    v_mfma_f32_16x16x32_bf16 v[192:195], v[36:39], v[32:35], v[192:195]
    ds_read_b64_tr_b16 v[64:65], v214 offset:6144
    ds_read_b64_tr_b16 v[66:67], v214 offset:6272
    ds_read_b128 v[68:71], v213 offset:384
    s_waitcnt lgkmcnt(9)
    v_mfma_f32_16x16x32_bf16 v[192:195], v[44:47], v[40:43], v[192:195]
    ds_read_b64_tr_b16 v[72:73], v214 offset:7168
    ds_read_b64_tr_b16 v[74:75], v214 offset:7296
    ds_read_b128 v[76:79], v213 offset:448
    s_waitcnt lgkmcnt(9)
    v_mfma_f32_16x16x32_bf16 v[192:195], v[52:55], v[48:51], v[192:195]
    ds_read_b64_tr_b16 v[80:81], v214 offset:8192
    ds_read_b64_tr_b16 v[82:83], v214 offset:8320
    ds_read_b128 v[84:87], v213 offset:512
    s_waitcnt lgkmcnt(9)
    v_mfma_f32_16x16x32_bf16 v[192:195], v[60:63], v[56:59], v[192:195]
    ds_read_b64_tr_b16 v[88:89], v214 offset:9216
    ds_read_b64_tr_b16 v[90:91], v214 offset:9344
    ds_read_b128 v[92:95], v213 offset:576
    s_waitcnt lgkmcnt(9)
    v_mfma_f32_16x16x32_bf16 v[192:195], v[68:71], v[64:67], v[192:195]
    ds_read_b64_tr_b16 v[96:97], v214 offset:10240
    ds_read_b64_tr_b16 v[98:99], v214 offset:10368
    ds_read_b128 v[100:103], v213 offset:640
    s_waitcnt lgkmcnt(9)
    v_mfma_f32_16x16x32_bf16 v[192:195], v[76:79], v[72:75], v[192:195]
    ds_read_b64_tr_b16 v[104:105], v214 offset:11264
    ds_read_b64_tr_b16 v[106:107], v214 offset:11392
    ds_read_b128 v[108:111], v213 offset:704
    s_waitcnt lgkmcnt(9)
    v_mfma_f32_16x16x32_bf16 v[192:195], v[84:87], v[80:83], v[192:195]
    ds_read_b64_tr_b16 v[112:113], v214 offset:12288
    ds_read_b64_tr_b16 v[114:115], v214 offset:12416
    ds_read_b128 v[116:119], v213 offset:768
    s_waitcnt lgkmcnt(9)
    v_mfma_f32_16x16x32_bf16 v[192:195], v[92:95], v[88:91], v[192:195]
    ds_read_b64_tr_b16 v[120:121], v214 offset:13312
    ds_read_b64_tr_b16 v[122:123], v214 offset:13440
    ds_read_b128 v[124:127], v213 offset:832
    s_waitcnt lgkmcnt(9)
    v_mfma_f32_16x16x32_bf16 v[192:195], v[100:103], v[96:99], v[192:195]
    ds_read_b64_tr_b16 v[128:129], v214 offset:14336
    ds_read_b64_tr_b16 v[130:131], v214 offset:14464
    ds_read_b128 v[132:135], v213 offset:896
    s_waitcnt lgkmcnt(9)
    v_mfma_f32_16x16x32_bf16 v[192:195], v[108:111], v[104:107], v[192:195]
    ds_read_b64_tr_b16 v[136:137], v214 offset:15360
    ds_read_b64_tr_b16 v[138:139], v214 offset:15488
    ds_read_b128 v[140:143], v213 offset:960
    s_waitcnt lgkmcnt(9)
    v_mfma_f32_16x16x32_bf16 v[192:195], v[116:119], v[112:115], v[192:195]
    s_waitcnt lgkmcnt(6)
    v_mfma_f32_16x16x32_bf16 v[192:195], v[124:127], v[120:123], v[192:195]
    s_waitcnt lgkmcnt(3)
    v_mfma_f32_16x16x32_bf16 v[192:195], v[132:135], v[128:131], v[192:195]
    s_waitcnt lgkmcnt(0)
    v_mfma_f32_16x16x32_bf16 v[192:195], v[140:143], v[136:139], v[192:195]
    s_mov_b32 s80, 0x5f800000
    s_nop 7
    v_mul_f32 v192, s80, v192
    v_mul_f32 v193, s80, v193
    v_mul_f32 v194, s80, v194
    v_mul_f32 v195, s80, v195
L_prodS:
    v_cvt_pk_bf16_f32 v218, v192, v193
    v_cvt_pk_bf16_f32 v219, v194, v195
    buffer_store_dwordx2 v[218:219], v216, s[44:47], s96 offen sc1
    v_mov_b32 v221, 156672
    s_mov_b64 exec, 1
    ds_write_b32 v221, v223
    s_mov_b64 exec, -1
    s_mov_b32 s91, 3200000
    v_mov_b32 v212, 156688
L_tagp:
    ds_read_b64 v[214:215], v212
    s_sub_u32 s91, s91, 1
    s_cmp_eq_u32 s91, 0
    s_cbranch_scc1 L_tagp_done
    s_waitcnt lgkmcnt(0)
    v_readfirstlane_b32 s86, v214
    v_readfirstlane_b32 s87, v215
    s_cmp_lg_u32 s86, 0
    s_cbranch_scc1 L_tagp_done
    s_sleep 3
    s_branch L_tagp
L_tagp_done:
    s_waitcnt lgkmcnt(0)
    v_mov_b32 v214, s86
    v_mov_b32 v215, s87
    s_mov_b64 exec, 1
    s_waitcnt vmcnt(0)
    buffer_store_dwordx2 v[214:215], off, s[44:47], s97 sc1
    s_mov_b64 exec, -1
    s_mov_b32 s90, 1
    s_branch L_tagged
L_np:
    s_waitcnt vmcnt(0)
    s_mov_b64 exec, 1
    ds_add_u32 v222, v223
    s_mov_b64 exec, -1
    s_cmp_eq_u32 s78, 3
    s_cbranch_scc0 L_tagged0
    s_mov_b32 s91, 400000
L_tag:
    buffer_load_dwordx2 v[222:223], off, s[68:71], 0 sc1
    s_sub_u32 s91, s91, 1
    s_cmp_eq_u32 s91, 0
    s_cbranch_scc1 L_tag_done
    s_waitcnt vmcnt(0)
    v_cmp_eq_u32 vcc, 0, v222
    s_nop 0
    s_cmp_eq_u64 vcc, 0
    s_cbranch_scc0 L_tag
L_tag_done:
    s_waitcnt vmcnt(0)
    v_mov_b32 v220, 156688
    ds_write_b64 v220, v[222:223]
    s_getreg_b32 s82, hwreg(HW_REG_XCC_ID, 0, 4)
    s_lshl_b32 s81, s2, 7
    s_add_u32 s81, s81, 4784128
    v_or_b32 v222, s82, v222
    s_mov_b64 exec, 1
    buffer_store_dwordx2 v[222:223], off, s[44:47], s81 sc1
    s_mov_b64 exec, -1
L_tagged0:
    s_mov_b32 s90, 0
    s_branch L_addr
L_tagged:
    s_mov_b32 s91, 3200000
    v_mov_b32 v8, 156688
L_tagx:
    ds_read_b64 v[10:11], v8
    s_sub_u32 s91, s91, 1
    s_cmp_eq_u32 s91, 0
    s_cbranch_scc1 L_tagx_done
    s_waitcnt lgkmcnt(0)
    v_readfirstlane_b32 s86, v10
    v_readfirstlane_b32 s87, v11
    s_cmp_lg_u32 s86, 0
    s_cbranch_scc1 L_tagx_done
    s_sleep 3
    s_branch L_tagx
L_tagx_done:
    s_waitcnt lgkmcnt(0)
    s_mov_b32 s91, 3200000
    v_mov_b32 v8, 156672
L_wkv:
    ds_read_b32 v9, v8
    s_sub_u32 s91, s91, 1
    s_cmp_eq_u32 s91, 0
    s_cbranch_scc1 L_wkv_done
    s_waitcnt lgkmcnt(0)
    v_readfirstlane_b32 s84, v9
    s_nop 0
    s_cmp_ge_u32 s84, 1
    s_cbranch_scc1 L_wkv_done
    s_sleep 3
    s_branch L_wkv
L_wkv_done:
    s_waitcnt lgkmcnt(0)
    v_and_b32 v194, 7, v1
    v_lshlrev_b32 v194, 7, v194
    s_lshl_b32 s96, s78, 10
    s_add_u32 s96, s96, 4718592
    s_lshl_b32 s81, s73, 12
    s_add_u32 s81, s81, s96
    s_lshl_b32 s85, s78, 12
    s_lshl_b32 s97, s73, 14
    s_barrier
    s_mov_b32 s91, 400000
L_pollK0:
    buffer_load_dwordx2 v[8:9], v194, s[44:47], s81 offen sc1
    s_sub_u32 s91, s91, 1
    s_cmp_eq_u32 s91, 0
    s_cbranch_scc1 L_pollK0_done
    s_waitcnt vmcnt(0)
    v_cmp_ne_u64 vcc, s[86:87], v[8:9]
    s_nop 0
    s_cmp_eq_u64 vcc, 0
    s_cbranch_scc0 L_pollK0
L_pollK0_done:
    s_waitcnt vmcnt(0)
    s_add_u32 m0, s85, 0
    s_add_u32 s88, s97, s85
    buffer_load_dwordx4 v2, s[44:47], s88 offen offset:0 sc1 lds
    buffer_load_dwordx4 v2, s[44:47], s88 offen offset:1024 sc1 lds
    buffer_load_dwordx4 v2, s[44:47], s88 offen offset:2048 sc1 lds
    buffer_load_dwordx4 v2, s[44:47], s88 offen offset:3072 sc1 lds
    s_add_u32 s97, s97, 16384
    s_and_b32 s97, s97, 0x1ffff
    s_cmp_eq_u32 s90, 1
    s_cbranch_scc0 L_addr_2
L_addr:
    s_mov_b32 s56, s16
    s_and_b32 s57, s17, 0xffff
    s_mov_b32 s58, 0x800000
    s_mov_b32 s59, 0x20000
    s_mov_b32 s60, s18
    s_and_b32 s61, s19, 0xffff
    s_mov_b32 s62, 0x800000
    s_mov_b32 s63, 0x20000
    s_mov_b32 s52, s14
    s_and_b32 s53, s15, 0xffff
    s_mov_b32 s54, 0x200000
    s_mov_b32 s55, 0x20000
    s_mov_b32 s48, s12
    s_and_b32 s49, s13, 0xffff
    s_mov_b32 s50, 0x80000
    s_mov_b32 s51, 0x20000
    s_mov_b32 s64, s24
    s_and_b32 s65, s25, 0xffff
    s_mov_b32 s66, 0x400000
    s_mov_b32 s67, 0x20000
    s_and_b32 s80, s74, 3
    s_lshl_b32 s98, s73, 2
    s_add_u32 s98, s98, s80
    s_lshr_b32 s80, s74, 2
    s_lshl_b32 s80, s80, 1
    s_lshr_b32 s99, s78, 1
    s_add_u32 s99, s99, s80
    s_and_b32 s100, s78, 1
    s_and_b32 s80, s74, 3
    s_lshl_b32 s80, s80, 1
    s_lshl_b32 s101, s73, 3
    s_add_u32 s101, s101, s80
    s_add_u32 s101, s101, s100
    s_mov_b32 s79, s99
    s_mov_b32 s32, s20
    s_and_b32 s33, s21, 0xffff
    s_mov_b32 s34, 0x80000
    s_mov_b32 s35, 0x20000
    s_mov_b32 s40, s22
    s_and_b32 s41, s23, 0xffff
    s_mov_b32 s42, 0x80000
    s_mov_b32 s43, 0x20000
    v_and_b32 v3, 31, v1
    v_lshrrev_b32 v4, 5, v1
    s_lshl_b32 s80, s100, 5
    v_add_u32 v5, s80, v3
    v_lshlrev_b32 v5, 5, v5
    v_add_u32 v13, s98, v5
    v_bfe_u32 v5, v1, 2, 2
    v_bfe_u32 v6, v1, 4, 1
    v_lshl_add_u32 v5, v6, 3, v5
    v_lshl_add_u32 v5, v4, 2, v5
    v_lshrrev_b32 v6, 4, v1
    v_xor_b32 v6, v6, v1
    v_and_b32 v6, 3, v6
    v_lshlrev_b32 v6, 4, v6
    s_and_b32 s80, s101, -2
    s_add_u32 s80, s80, s78
    s_lshl_b32 s80, s80, 10
    s_and_b32 s81, s79, -2
    s_add_u32 s81, s81, s100
    s_lshl_b32 s81, s81, 14
    s_add_u32 s82, s80, 0x100000
    s_cmp_lt_u32 s78, 2
    s_cselect_b32 s83, 16, 10
    s_cselect_b32 s80, s80, s81
    s_cselect_b32 s82, s82, s81
    s_cselect_b64 s[92:93], s[14:15], s[20:21]
    s_cselect_b64 s[94:95], s[14:15], s[22:23]
    v_lshlrev_b32 v5, s83, v5
    v_add_u32 v5, v5, v6
    v_add_u32 v7, s80, v5
    v_mov_b32 v241, s93
    v_add_co_u32 v240, vcc, s92, v7
    v_add_u32 v7, s82, v5
    v_mov_b32 v243, s95
    v_addc_co_u32 v241, vcc, 0, v241, vcc
    v_add_co_u32 v242, vcc, s94, v7
    s_lshl_b32 s81, s81, 2
    s_add_u32 s81, s81, s78
    v_addc_co_u32 v243, vcc, 0, v243, vcc
    s_cmp_eq_u32 s81, 2
    s_cbranch_scc0 L_nospec0
    s_mov_b64 exec, 15
    v_add_u32 v7, 0x40000, v6
    v_mov_b32 v243, s21
    v_add_co_u32 v242, vcc, s20, v7
    s_nop 1
    v_addc_co_u32 v243, vcc, 0, v243, vcc
    s_mov_b64 exec, -1
L_nospec0:
    v_bfe_u32 v5, v3, 2, 2
    v_xor_b32 v5, v5, v4
    v_lshlrev_b32 v5, 4, v5
    v_lshl_add_u32 v5, v3, 6, v5
    s_lshl_b32 s80, s100, 11
    s_add_u32 s80, s80, 131072
    v_add_u32 v244, s80, v5
    v_xor_b32 v245, 32, v244
    s_lshr_b32 s80, s78, 1
    s_lshl_b32 s80, s80, 11
    s_add_u32 s80, s80, 135168
    v_add_u32 v246, s80, v5
    v_xor_b32 v247, 32, v246
    s_lshl_b32 s80, s78, 11
    s_add_u32 s80, s80, 131072
    v_bfe_u32 v5, v3, 2, 2
    v_lshlrev_b32 v7, 1, v4
    v_xor_b32 v5, v5, v7
    v_lshlrev_b32 v5, 4, v5
    v_lshl_add_u32 v5, v3, 6, v5
    v_add_u32 v250, s80, v5
    v_xor_b32 v253, 16, v250
    v_add_u32 v16, s80, v2
    v_lshrrev_b32 v5, 2, v1
    v_mul_u32_u24 v5, 73728, v5
    v_add_u32 v17, v5, v6
    v_mul_u32_u24 v8, 73728, v3
    v_lshl_add_u32 v15, v4, 5, v8
    v_lshrrev_b32 v8, 3, v1
    v_and_b32 v9, 7, v1
    v_bfe_u32 v10, v1, 4, 1
    v_lshlrev_b32 v10, 2, v10
    v_xor_b32 v9, v9, v10
    v_lshlrev_b32 v9, 4, v9
    v_lshl_add_u32 v14, v8, 10, v9
    v_bfe_u32 v9, v1, 2, 2
    v_lshl_add_u32 v9, v4, 3, v9
    v_lshlrev_b32 v9, 7, v9
    v_and_b32 v10, 1, v1
    v_bfe_u32 v11, v1, 4, 1
    v_lshl_add_u32 v10, v10, 1, v11
    s_lshr_b32 s80, s78, 1
    s_lshl_b32 s80, s80, 2
    v_add_u32 v10, s80, v10
    v_bfe_u32 v11, v1, 3, 1
    v_lshlrev_b32 v11, 2, v11
    v_xor_b32 v10, v10, v11
    v_lshl_add_u32 v9, v10, 4, v9
    v_bfe_u32 v11, v1, 1, 1
    v_lshl_add_u32 v9, v11, 3, v9
    v_add_u32 v0, 131072, v9
    s_lshl_b32 s83, s75, 1
    s_and_b32 s84, s78, 1
    s_add_u32 s83, s83, s84
    s_lshl_b32 s83, s83, 5
    v_add_u32 v8, s83, v3
    v_lshlrev_b32 v8, 11, v8
    v_lshl_add_u32 v6, v4, 5, v8
    s_lshl_b32 s83, s84, 15
    v_add_u32 v5, s83, v2
    v_lshlrev_b32 v7, 7, v1
    v_and_b32 v8, 3, v3
    v_bfe_u32 v9, v3, 2, 1
    v_lshl_add_u32 v8, v9, 4, v8
    v_lshrrev_b32 v9, 3, v3
    v_lshl_add_u32 v8, v9, 2, v8
    s_lshl_b32 s80, s99, 5
    v_add_u32 v8, s80, v8
    v_sub_u32 v9, 0x200, v8
    v_sub_u32 v10, 0x800, v13
    v_and_b32 v10, 0x7ff, v10
    s_cmp_lt_u32 s99, 8
    s_cselect_b64 vcc, 0, -1
    v_cndmask_b32 v8, v8, v9, vcc
    v_cndmask_b32 v11, v13, v10, vcc
    v_lshlrev_b32 v10, 12, v10
    v_lshl_add_u32 v252, v4, 6, v10
    v_lshlrev_b32 v10, 12, v13
    v_lshl_add_u32 v251, v4, 6, v10
    v_lshlrev_b32 v10, 18, v3
    v_lshl_add_u32 v13, v4, 4, v10
    v_lshrrev_b32 v10, 3, v1
    v_lshlrev_b32 v10, 5, v10
    v_and_b32 v9, 7, v1
    v_add_u32 v10, v10, v9
    v_lshlrev_b32 v12, 7, v10
    v_lshlrev_b32 v11, 11, v11
    v_lshl_add_u32 v3, v4, 5, v11
    v_mul_u32_u24 v9, 36864, v4
    v_lshl_add_u32 v4, v8, 2, v9
    s_cmp_eq_u32 s90, 0
    s_mov_b32 s90, 2
    s_cbranch_scc1 L_tagged
L_addr_2:
    v_mov_b32 v248, 156716
    v_mov_b32 v249, 1
    s_waitcnt vmcnt(0)
    s_barrier
    s_mov_b32 s91, 400000
L_pollKV:
    buffer_load_dwordx2 v[8:9], v12, s[44:47], s96 offen sc1
    s_sub_u32 s91, s91, 1
    s_cmp_eq_u32 s91, 0
    s_cbranch_scc1 L_pollKV_done
    s_waitcnt vmcnt(0)
    v_cmp_ne_u64 vcc, s[86:87], v[8:9]
    s_nop 0
    s_cmp_eq_u64 vcc, 0
    s_cbranch_scc1 L_pollKV_done
    s_sleep 1
    s_branch L_pollKV
L_pollKV_done:
    s_waitcnt vmcnt(0)
L_kv_all:
    s_setprio 0
    s_add_u32 m0, s85, 16384
    s_add_u32 s88, s97, s85
    buffer_load_dwordx4 v2, s[44:47], s88 offen offset:0 sc1 lds
    buffer_load_dwordx4 v2, s[44:47], s88 offen offset:1024 sc1 lds
    buffer_load_dwordx4 v2, s[44:47], s88 offen offset:2048 sc1 lds
    buffer_load_dwordx4 v2, s[44:47], s88 offen offset:3072 sc1 lds
    s_add_u32 s97, s97, 16384
    s_and_b32 s97, s97, 0x1ffff
    s_add_u32 m0, s85, 32768
    s_add_u32 s88, s97, s85
    buffer_load_dwordx4 v2, s[44:47], s88 offen offset:0 sc1 lds
    buffer_load_dwordx4 v2, s[44:47], s88 offen offset:1024 sc1 lds
    buffer_load_dwordx4 v2, s[44:47], s88 offen offset:2048 sc1 lds
    buffer_load_dwordx4 v2, s[44:47], s88 offen offset:3072 sc1 lds
    s_add_u32 s97, s97, 16384
    s_and_b32 s97, s97, 0x1ffff
    s_waitcnt vmcnt(4)
    s_mov_b64 exec, 1
    ds_add_u32 v248, v249 offset:0
    s_mov_b64 exec, -1
    s_add_u32 m0, s85, 49152
    s_add_u32 s88, s97, s85
    buffer_load_dwordx4 v2, s[44:47], s88 offen offset:0 sc1 lds
    buffer_load_dwordx4 v2, s[44:47], s88 offen offset:1024 sc1 lds
    buffer_load_dwordx4 v2, s[44:47], s88 offen offset:2048 sc1 lds
    buffer_load_dwordx4 v2, s[44:47], s88 offen offset:3072 sc1 lds
    s_add_u32 s97, s97, 16384
    s_and_b32 s97, s97, 0x1ffff
    s_add_u32 m0, s85, 65536
    s_add_u32 s88, s97, s85
    buffer_load_dwordx4 v2, s[44:47], s88 offen offset:0 sc1 lds
    buffer_load_dwordx4 v2, s[44:47], s88 offen offset:1024 sc1 lds
    buffer_load_dwordx4 v2, s[44:47], s88 offen offset:2048 sc1 lds
    buffer_load_dwordx4 v2, s[44:47], s88 offen offset:3072 sc1 lds
    s_add_u32 s97, s97, 16384
    s_and_b32 s97, s97, 0x1ffff
    s_add_u32 m0, s85, 81920
    s_add_u32 s88, s97, s85
    buffer_load_dwordx4 v2, s[44:47], s88 offen offset:0 sc1 lds
    buffer_load_dwordx4 v2, s[44:47], s88 offen offset:1024 sc1 lds
    buffer_load_dwordx4 v2, s[44:47], s88 offen offset:2048 sc1 lds
    buffer_load_dwordx4 v2, s[44:47], s88 offen offset:3072 sc1 lds
    s_add_u32 s97, s97, 16384
    s_and_b32 s97, s97, 0x1ffff
    s_add_u32 m0, s85, 98304
    s_add_u32 s88, s97, s85
    buffer_load_dwordx4 v2, s[44:47], s88 offen offset:0 sc1 lds
    buffer_load_dwordx4 v2, s[44:47], s88 offen offset:1024 sc1 lds
    buffer_load_dwordx4 v2, s[44:47], s88 offen offset:2048 sc1 lds
    buffer_load_dwordx4 v2, s[44:47], s88 offen offset:3072 sc1 lds
    s_add_u32 s97, s97, 16384
    s_and_b32 s97, s97, 0x1ffff
    s_add_u32 m0, s85, 114688
    s_add_u32 s88, s97, s85
    buffer_load_dwordx4 v2, s[44:47], s88 offen offset:0 sc1 lds
    buffer_load_dwordx4 v2, s[44:47], s88 offen offset:1024 sc1 lds
    buffer_load_dwordx4 v2, s[44:47], s88 offen offset:2048 sc1 lds
    buffer_load_dwordx4 v2, s[44:47], s88 offen offset:3072 sc1 lds
    s_lshl_b32 s80, s74, 13
    s_cmp_eq_u32 s78, 1
    s_cbranch_scc1 L_pf1
    s_cmp_eq_u32 s78, 2
    s_cbranch_scc1 L_pf2
    s_cmp_eq_u32 s78, 3
    s_cbranch_scc1 L_pf3
    s_lshl_b32 s80, s74, 16
    s_lshl_b32 s81, s73, 13
    s_add_u32 s80, s80, s81
    buffer_load_dword v232, v7, s[52:55], s80 offen
    s_branch L_pf4
L_pf1:
    buffer_load_dword v232, v7, s[32:35], s80 offen
    s_branch L_pf4
L_pf2:
    buffer_load_dword v232, v7, s[40:43], s80 offen
    s_branch L_pf4
L_pf3:
    s_lshl_b32 s80, s74, 14
    buffer_load_dword v232, v7, s[48:51], s80 offen
L_pf4:
    s_lshl_b32 s30, s78, 11
    s_add_u32 s30, s30, 131072
    s_lshl_b32 s31, s76, 7
    s_lshl_b32 s81, s78, 14
    s_add_u32 s96, s31, s81
    s_lshr_b32 s81, s78, 1
    s_lshl_b32 s81, s81, 6
    s_add_u32 s31, s31, s81
    s_add_u32 m0, s30, 0
    s_nop 0
    global_load_lds_dwordx4 v[240:241], off offset:0
    s_add_u32 m0, s30, 1024
    s_nop 0
    global_load_lds_dwordx4 v[242:243], off offset:0
    s_add_u32 m0, s30, 8128
    s_nop 0
    global_load_lds_dwordx4 v[240:241], off offset:64
    s_add_u32 m0, s30, 9152
    s_nop 0
    global_load_lds_dwordx4 v[242:243], off offset:64
    s_waitcnt vmcnt(5)
    s_mov_b64 exec, 1
    ds_add_u32 v248, v249 offset:4
    s_mov_b64 exec, -1
    s_cmp_eq_u32 s78, 3
    s_cbranch_scc0 L_pf5
    s_add_u32 s80, s80, 8192
    buffer_load_dword v233, v7, s[48:51], s80 offen
L_pf5:
    s_waitcnt vmcnt(2) lgkmcnt(0)
    s_mov_b64 exec, 1
    ds_add_u32 v248, v249 offset:8
    s_mov_b64 exec, -1
    s_mov_b32 s91, 3200000
L_st0:
    ds_read_b32 v8, v248 offset:8
    s_sub_u32 s91, s91, 1
    s_cbranch_scc1 L_st0_done
    s_waitcnt lgkmcnt(0)
    s_setprio 2
    v_readfirstlane_b32 s84, v8
    s_setprio 0
    s_cmp_ge_u32 s84, 4
    s_cbranch_scc1 L_st0_done
    s_sleep 1
    s_branch L_st0
L_st0_done:
    s_add_u32 m0, s30, 16256
    s_nop 0
    global_load_lds_dwordx4 v[240:241], off offset:128
    s_add_u32 m0, s30, 17280
    s_nop 0
    global_load_lds_dwordx4 v[242:243], off offset:128
    ds_read_b128 v[208:211], v244 offset:0
    ds_read_b128 v[216:219], v246 offset:0
    ds_read_b128 v[212:215], v245 offset:0
    ds_read_b128 v[220:223], v247 offset:0
    s_waitcnt vmcnt(2) lgkmcnt(0)
    s_mov_b64 exec, 1
    ds_add_u32 v248, v249 offset:8
    s_mov_b64 exec, -1
    v_mfma_f32_32x32x16_bf16 v[192:207], v[208:211], v[216:219], 0
    v_mfma_f32_32x32x16_bf16 v[192:207], v[212:215], v[220:223], v[192:207]
    s_mov_b32 s91, 3200000
L_st1:
    ds_read_b32 v8, v248 offset:8
    s_sub_u32 s91, s91, 1
    s_cbranch_scc1 L_st1_done
    s_waitcnt lgkmcnt(0)
    s_setprio 2
    v_readfirstlane_b32 s84, v8
    s_setprio 0
    s_cmp_ge_u32 s84, 8
    s_cbranch_scc1 L_st1_done
    s_sleep 1
    s_branch L_st1
L_st1_done:
    s_add_u32 m0, s30, -192
    s_nop 0
    global_load_lds_dwordx4 v[240:241], off offset:192
    s_add_u32 m0, s30, 832
    s_nop 0
    global_load_lds_dwordx4 v[242:243], off offset:192
    ds_read_b128 v[208:211], v244 offset:8192
    ds_read_b128 v[216:219], v246 offset:8192
    ds_read_b128 v[212:215], v245 offset:8192
    ds_read_b128 v[220:223], v247 offset:8192
    s_waitcnt vmcnt(2) lgkmcnt(0)
    s_mov_b64 exec, 1
    ds_add_u32 v248, v249 offset:8
    s_mov_b64 exec, -1
    v_mfma_f32_32x32x16_bf16 v[192:207], v[208:211], v[216:219], v[192:207]
    v_mfma_f32_32x32x16_bf16 v[192:207], v[212:215], v[220:223], v[192:207]
    s_mov_b32 s91, 3200000
L_st2:
    ds_read_b32 v8, v248 offset:8
    s_sub_u32 s91, s91, 1
    s_cbranch_scc1 L_st2_done
    s_waitcnt lgkmcnt(0)
    s_setprio 2
    v_readfirstlane_b32 s84, v8
    s_setprio 0
    s_cmp_ge_u32 s84, 12
    s_cbranch_scc1 L_st2_done
    s_sleep 1
    s_branch L_st2
L_st2_done:
    s_add_u32 m0, s30, 7936
    s_nop 0
    global_load_lds_dwordx4 v[240:241], off offset:256
    s_add_u32 m0, s30, 8960
    s_nop 0
    global_load_lds_dwordx4 v[242:243], off offset:256
    ds_read_b128 v[208:211], v244 offset:16384
    ds_read_b128 v[216:219], v246 offset:16384
    ds_read_b128 v[212:215], v245 offset:16384
    ds_read_b128 v[220:223], v247 offset:16384
    s_waitcnt vmcnt(2) lgkmcnt(0)
    s_mov_b64 exec, 1
    ds_add_u32 v248, v249 offset:8
    s_mov_b64 exec, -1
    v_mfma_f32_32x32x16_bf16 v[192:207], v[208:211], v[216:219], v[192:207]
    v_mfma_f32_32x32x16_bf16 v[192:207], v[212:215], v[220:223], v[192:207]
    s_mov_b32 s91, 3200000
L_st3:
    ds_read_b32 v8, v248 offset:8
    s_sub_u32 s91, s91, 1
    s_cbranch_scc1 L_st3_done
    s_waitcnt lgkmcnt(0)
    s_setprio 2
    v_readfirstlane_b32 s84, v8
    s_setprio 0
    s_cmp_ge_u32 s84, 16
    s_cbranch_scc1 L_st3_done
    s_sleep 1
    s_branch L_st3
L_st3_done:
    s_add_u32 m0, s30, 16064
    s_nop 0
    global_load_lds_dwordx4 v[240:241], off offset:320
    s_add_u32 m0, s30, 17088
    s_nop 0
    global_load_lds_dwordx4 v[242:243], off offset:320
    ds_read_b128 v[208:211], v244 offset:0
    ds_read_b128 v[216:219], v246 offset:0
    ds_read_b128 v[212:215], v245 offset:0
    ds_read_b128 v[220:223], v247 offset:0
    s_waitcnt vmcnt(2) lgkmcnt(0)
    s_mov_b64 exec, 1
    ds_add_u32 v248, v249 offset:8
    s_mov_b64 exec, -1
    v_mfma_f32_32x32x16_bf16 v[192:207], v[208:211], v[216:219], v[192:207]
    v_mfma_f32_32x32x16_bf16 v[192:207], v[212:215], v[220:223], v[192:207]
    s_mov_b32 s91, 3200000
L_st4:
    ds_read_b32 v8, v248 offset:8
    s_sub_u32 s91, s91, 1
    s_cbranch_scc1 L_st4_done
    s_waitcnt lgkmcnt(0)
    s_setprio 2
    v_readfirstlane_b32 s84, v8
    s_setprio 0
    s_cmp_ge_u32 s84, 20
    s_cbranch_scc1 L_st4_done
    s_sleep 1
    s_branch L_st4
L_st4_done:
    s_add_u32 m0, s30, -384
    s_nop 0
    global_load_lds_dwordx4 v[240:241], off offset:384
    s_add_u32 m0, s30, 640
    s_nop 0
    global_load_lds_dwordx4 v[242:243], off offset:384
    ds_read_b128 v[208:211], v244 offset:8192
    ds_read_b128 v[216:219], v246 offset:8192
    ds_read_b128 v[212:215], v245 offset:8192
    ds_read_b128 v[220:223], v247 offset:8192
    s_waitcnt vmcnt(2) lgkmcnt(0)
    s_mov_b64 exec, 1
    ds_add_u32 v248, v249 offset:8
    s_mov_b64 exec, -1
    v_mfma_f32_32x32x16_bf16 v[192:207], v[208:211], v[216:219], v[192:207]
    v_mfma_f32_32x32x16_bf16 v[192:207], v[212:215], v[220:223], v[192:207]
    s_mov_b32 s91, 3200000
L_st5:
    ds_read_b32 v8, v248 offset:8
    s_sub_u32 s91, s91, 1
    s_cbranch_scc1 L_st5_done
    s_waitcnt lgkmcnt(0)
    s_setprio 2
    v_readfirstlane_b32 s84, v8
    s_setprio 0
    s_cmp_ge_u32 s84, 24
    s_cbranch_scc1 L_st5_done
    s_sleep 1
    s_branch L_st5
L_st5_done:
    s_add_u32 m0, s30, 7744
    s_nop 0
    global_load_lds_dwordx4 v[240:241], off offset:448
    s_add_u32 m0, s30, 8768
    s_nop 0
    global_load_lds_dwordx4 v[242:243], off offset:448
    ds_read_b128 v[208:211], v244 offset:16384
    ds_read_b128 v[216:219], v246 offset:16384
    ds_read_b128 v[212:215], v245 offset:16384
    ds_read_b128 v[220:223], v247 offset:16384
    s_waitcnt vmcnt(2) lgkmcnt(0)
    s_mov_b64 exec, 1
    ds_add_u32 v248, v249 offset:8
    s_mov_b64 exec, -1
    v_mfma_f32_32x32x16_bf16 v[192:207], v[208:211], v[216:219], v[192:207]
    v_mfma_f32_32x32x16_bf16 v[192:207], v[212:215], v[220:223], v[192:207]
    s_mov_b32 s91, 3200000
L_st6:
    ds_read_b32 v8, v248 offset:8
    s_sub_u32 s91, s91, 1
    s_cbranch_scc1 L_st6_done
    s_waitcnt lgkmcnt(0)
    s_setprio 2
    v_readfirstlane_b32 s84, v8
    s_setprio 0
    s_cmp_ge_u32 s84, 28
    s_cbranch_scc1 L_st6_done
    s_sleep 1
    s_branch L_st6
L_st6_done:
    s_add_u32 m0, s30, 15872
    s_nop 0
    global_load_lds_dwordx4 v[240:241], off offset:512
    s_add_u32 m0, s30, 16896
    s_nop 0
    global_load_lds_dwordx4 v[242:243], off offset:512
    ds_read_b128 v[208:211], v244 offset:0
    ds_read_b128 v[216:219], v246 offset:0
    ds_read_b128 v[212:215], v245 offset:0
    ds_read_b128 v[220:223], v247 offset:0
    buffer_load_dwordx4 v[176:179], v13, s[56:59], 0 offen offset:0
    buffer_load_dwordx4 v[180:183], v13, s[56:59], 0 offen offset:32
    buffer_load_dwordx4 v[184:187], v13, s[60:63], 0 offen offset:0
    buffer_load_dwordx4 v[188:191], v13, s[60:63], 0 offen offset:32
    s_waitcnt vmcnt(6) lgkmcnt(0)
    s_mov_b64 exec, 1
    ds_add_u32 v248, v249 offset:8
    s_mov_b64 exec, -1
    v_mfma_f32_32x32x16_bf16 v[192:207], v[208:211], v[216:219], v[192:207]
    v_mfma_f32_32x32x16_bf16 v[192:207], v[212:215], v[220:223], v[192:207]
    s_mov_b32 s91, 3200000
L_st7:
    ds_read_b32 v8, v248 offset:8
    s_sub_u32 s91, s91, 1
    s_cbranch_scc1 L_st7_done
    s_waitcnt lgkmcnt(0)
    s_setprio 2
    v_readfirstlane_b32 s84, v8
    s_setprio 0
    s_cmp_ge_u32 s84, 32
    s_cbranch_scc1 L_st7_done
    s_sleep 1
    s_branch L_st7
L_st7_done:
    s_add_u32 m0, s30, -576
    s_nop 0
    global_load_lds_dwordx4 v[240:241], off offset:576
    s_add_u32 m0, s30, 448
    s_nop 0
    global_load_lds_dwordx4 v[242:243], off offset:576
    ds_read_b128 v[208:211], v244 offset:8192
    ds_read_b128 v[216:219], v246 offset:8192
    ds_read_b128 v[212:215], v245 offset:8192
    ds_read_b128 v[220:223], v247 offset:8192
    s_waitcnt vmcnt(6) lgkmcnt(0)
    s_mov_b64 exec, 1
    ds_add_u32 v248, v249 offset:8
    s_mov_b64 exec, -1
    v_mfma_f32_32x32x16_bf16 v[192:207], v[208:211], v[216:219], v[192:207]
    v_mfma_f32_32x32x16_bf16 v[192:207], v[212:215], v[220:223], v[192:207]
    s_mov_b32 s91, 3200000
L_st8:
    ds_read_b32 v8, v248 offset:8
    s_sub_u32 s91, s91, 1
    s_cbranch_scc1 L_st8_done
    s_waitcnt lgkmcnt(0)
    s_setprio 2
    v_readfirstlane_b32 s84, v8
    s_setprio 0
    s_cmp_ge_u32 s84, 36
    s_cbranch_scc1 L_st8_done
    s_sleep 1
    s_branch L_st8
L_st8_done:
    s_add_u32 m0, s30, 7552
    s_nop 0
    global_load_lds_dwordx4 v[240:241], off offset:640
    s_add_u32 m0, s30, 8576
    s_nop 0
    global_load_lds_dwordx4 v[242:243], off offset:640
    ds_read_b128 v[208:211], v244 offset:16384
    ds_read_b128 v[216:219], v246 offset:16384
    ds_read_b128 v[212:215], v245 offset:16384
    ds_read_b128 v[220:223], v247 offset:16384
    s_waitcnt vmcnt(2) lgkmcnt(0)
    s_mov_b64 exec, 1
    ds_add_u32 v248, v249 offset:8
    s_mov_b64 exec, -1
    v_mfma_f32_32x32x16_bf16 v[192:207], v[208:211], v[216:219], v[192:207]
    v_mfma_f32_32x32x16_bf16 v[192:207], v[212:215], v[220:223], v[192:207]
    s_mov_b32 s91, 3200000
L_st9:
    ds_read_b32 v8, v248 offset:8
    s_sub_u32 s91, s91, 1
    s_cbranch_scc1 L_st9_done
    s_waitcnt lgkmcnt(0)
    s_setprio 2
    v_readfirstlane_b32 s84, v8
    s_setprio 0
    s_cmp_ge_u32 s84, 40
    s_cbranch_scc1 L_st9_done
    s_sleep 1
    s_branch L_st9
L_st9_done:
    s_add_u32 m0, s30, 15680
    s_nop 0
    global_load_lds_dwordx4 v[240:241], off offset:704
    s_add_u32 m0, s30, 16704
    s_nop 0
    global_load_lds_dwordx4 v[242:243], off offset:704
    ds_read_b128 v[208:211], v244 offset:0
    ds_read_b128 v[216:219], v246 offset:0
    ds_read_b128 v[212:215], v245 offset:0
    ds_read_b128 v[220:223], v247 offset:0
    s_waitcnt vmcnt(2) lgkmcnt(0)
    s_mov_b64 exec, 1
    ds_add_u32 v248, v249 offset:8
    s_mov_b64 exec, -1
    v_mfma_f32_32x32x16_bf16 v[192:207], v[208:211], v[216:219], v[192:207]
    v_mfma_f32_32x32x16_bf16 v[192:207], v[212:215], v[220:223], v[192:207]
    s_mov_b32 s91, 3200000
L_st10:
    ds_read_b32 v8, v248 offset:8
    s_sub_u32 s91, s91, 1
    s_cbranch_scc1 L_st10_done
    s_waitcnt lgkmcnt(0)
    s_setprio 2
    v_readfirstlane_b32 s84, v8
    s_setprio 0
    s_cmp_ge_u32 s84, 44
    s_cbranch_scc1 L_st10_done
    s_sleep 1
    s_branch L_st10
L_st10_done:
    s_add_u32 m0, s30, -768
    s_nop 0
    global_load_lds_dwordx4 v[240:241], off offset:768
    s_add_u32 m0, s30, 256
    s_nop 0
    global_load_lds_dwordx4 v[242:243], off offset:768
    ds_read_b128 v[208:211], v244 offset:8192
    ds_read_b128 v[216:219], v246 offset:8192
    ds_read_b128 v[212:215], v245 offset:8192
    ds_read_b128 v[220:223], v247 offset:8192
    s_waitcnt vmcnt(2) lgkmcnt(0)
    s_mov_b64 exec, 1
    ds_add_u32 v248, v249 offset:8
    s_mov_b64 exec, -1
    v_mfma_f32_32x32x16_bf16 v[192:207], v[208:211], v[216:219], v[192:207]
    v_mfma_f32_32x32x16_bf16 v[192:207], v[212:215], v[220:223], v[192:207]
    s_mov_b32 s91, 3200000
L_st11:
    ds_read_b32 v8, v248 offset:8
    s_sub_u32 s91, s91, 1
    s_cbranch_scc1 L_st11_done
    s_waitcnt lgkmcnt(0)
    s_setprio 2
    v_readfirstlane_b32 s84, v8
    s_setprio 0
    s_cmp_ge_u32 s84, 48
    s_cbranch_scc1 L_st11_done
    s_sleep 1
    s_branch L_st11
L_st11_done:
    s_add_u32 m0, s30, 7360
    s_nop 0
    global_load_lds_dwordx4 v[240:241], off offset:832
    s_add_u32 m0, s30, 8384
    s_nop 0
    global_load_lds_dwordx4 v[242:243], off offset:832
    ds_read_b128 v[208:211], v244 offset:16384
    ds_read_b128 v[216:219], v246 offset:16384
    ds_read_b128 v[212:215], v245 offset:16384
    ds_read_b128 v[220:223], v247 offset:16384
    s_waitcnt vmcnt(2) lgkmcnt(0)
    s_mov_b64 exec, 1
    ds_add_u32 v248, v249 offset:8
    s_mov_b64 exec, -1
    v_mfma_f32_32x32x16_bf16 v[192:207], v[208:211], v[216:219], v[192:207]
    v_mfma_f32_32x32x16_bf16 v[192:207], v[212:215], v[220:223], v[192:207]
    s_mov_b32 s91, 3200000
L_st12:
    ds_read_b32 v8, v248 offset:8
    s_sub_u32 s91, s91, 1
    s_cbranch_scc1 L_st12_done
    s_waitcnt lgkmcnt(0)
    s_setprio 2
    v_readfirstlane_b32 s84, v8
    s_setprio 0
    s_cmp_ge_u32 s84, 52
    s_cbranch_scc1 L_st12_done
    s_sleep 1
    s_branch L_st12
L_st12_done:
    s_add_u32 m0, s30, 15488
    s_nop 0
    global_load_lds_dwordx4 v[240:241], off offset:896
    s_add_u32 m0, s30, 16512
    s_nop 0
    global_load_lds_dwordx4 v[242:243], off offset:896
    ds_read_b128 v[208:211], v244 offset:0
    ds_read_b128 v[216:219], v246 offset:0
    ds_read_b128 v[212:215], v245 offset:0
    ds_read_b128 v[220:223], v247 offset:0
    s_waitcnt vmcnt(2) lgkmcnt(0)
    s_mov_b64 exec, 1
    ds_add_u32 v248, v249 offset:8
    s_mov_b64 exec, -1
    v_mfma_f32_32x32x16_bf16 v[192:207], v[208:211], v[216:219], v[192:207]
    v_mfma_f32_32x32x16_bf16 v[192:207], v[212:215], v[220:223], v[192:207]
    s_mov_b32 s91, 3200000
L_st13:
    ds_read_b32 v8, v248 offset:8
    s_sub_u32 s91, s91, 1
    s_cbranch_scc1 L_st13_done
    s_waitcnt lgkmcnt(0)
    s_setprio 2
    v_readfirstlane_b32 s84, v8
    s_setprio 0
    s_cmp_ge_u32 s84, 56
    s_cbranch_scc1 L_st13_done
    s_sleep 1
    s_branch L_st13
L_st13_done:
    s_add_u32 m0, s30, -960
    s_nop 0
    global_load_lds_dwordx4 v[240:241], off offset:960
    s_add_u32 m0, s30, 64
    s_nop 0
    global_load_lds_dwordx4 v[242:243], off offset:960
    ds_read_b128 v[208:211], v244 offset:8192
    ds_read_b128 v[216:219], v246 offset:8192
    ds_read_b128 v[212:215], v245 offset:8192
    ds_read_b128 v[220:223], v247 offset:8192
    s_waitcnt vmcnt(2) lgkmcnt(0)
    s_mov_b64 exec, 1
    ds_add_u32 v248, v249 offset:8
    s_mov_b64 exec, -1
    v_mfma_f32_32x32x16_bf16 v[192:207], v[208:211], v[216:219], v[192:207]
    v_mfma_f32_32x32x16_bf16 v[192:207], v[212:215], v[220:223], v[192:207]
    s_mov_b32 s91, 3200000
L_st14:
    ds_read_b32 v8, v248 offset:8
    s_sub_u32 s91, s91, 1
    s_cbranch_scc1 L_st14_done
    s_waitcnt lgkmcnt(0)
    s_setprio 2
    v_readfirstlane_b32 s84, v8
    s_setprio 0
    s_cmp_ge_u32 s84, 60
    s_cbranch_scc1 L_st14_done
    s_sleep 1
    s_branch L_st14
L_st14_done:
    ds_read_b128 v[208:211], v244 offset:16384
    ds_read_b128 v[216:219], v246 offset:16384
    ds_read_b128 v[212:215], v245 offset:16384
    ds_read_b128 v[220:223], v247 offset:16384
    s_waitcnt vmcnt(0) lgkmcnt(0)
    s_mov_b64 exec, 1
    ds_add_u32 v248, v249 offset:8
    s_mov_b64 exec, -1
    v_mfma_f32_32x32x16_bf16 v[192:207], v[208:211], v[216:219], v[192:207]
    v_mfma_f32_32x32x16_bf16 v[192:207], v[212:215], v[220:223], v[192:207]
    s_mov_b32 s91, 3200000
L_st15:
    ds_read_b32 v8, v248 offset:8
    s_sub_u32 s91, s91, 1
    s_cbranch_scc1 L_st15_done
    s_waitcnt lgkmcnt(0)
    s_setprio 2
    v_readfirstlane_b32 s84, v8
    s_setprio 0
    s_cmp_ge_u32 s84, 64
    s_cbranch_scc1 L_st15_done
    s_sleep 1
    s_branch L_st15
L_st15_done:
    ds_read_b128 v[208:211], v244 offset:0
    ds_read_b128 v[216:219], v246 offset:0
    ds_read_b128 v[212:215], v245 offset:0
    ds_read_b128 v[220:223], v247 offset:0
    s_waitcnt lgkmcnt(0)
    v_mfma_f32_32x32x16_bf16 v[192:207], v[208:211], v[216:219], v[192:207]
    v_mfma_f32_32x32x16_bf16 v[192:207], v[212:215], v[220:223], v[192:207]
    s_mul_i32 s80, s101, 1152
    s_lshl_b32 s81, s79, 6
    s_add_u32 s80, s80, s81
    s_add_u32 s80, s80, 2359296
    s_nop 6
    s_setprio 2
    v_cvt_pk_bf16_f32 v144, v192, v193
    v_cvt_pk_bf16_f32 v145, v194, v195
    v_cvt_pk_bf16_f32 v146, v196, v197
    v_cvt_pk_bf16_f32 v147, v198, v199
    v_cvt_pk_bf16_f32 v148, v200, v201
    v_cvt_pk_bf16_f32 v149, v202, v203
    v_cvt_pk_bf16_f32 v150, v204, v205
    v_cvt_pk_bf16_f32 v151, v206, v207
    s_setprio 0
    s_nop 0
    v_mfma_f32_32x32x16_bf16 v[208:223], v[144:147], v[176:179], 0
    v_mfma_f32_32x32x16_bf16 v[224:239], v[144:147], v[184:187], 0
    v_mfma_f32_32x32x16_bf16 v[208:223], v[148:151], v[180:183], v[208:223]
    v_mfma_f32_32x32x16_bf16 v[224:239], v[148:151], v[188:191], v[224:239]
    s_nop 10
    s_setprio 2
    v_sub_f32 v192, v208, v232
    v_add_f32 v200, v224, v216
    v_sub_f32 v193, v209, v233
    v_add_f32 v201, v225, v217
    v_sub_f32 v194, v210, v234
    v_add_f32 v202, v226, v218
    v_sub_f32 v195, v211, v235
    v_add_f32 v203, v227, v219
    v_sub_f32 v196, v212, v236
    v_add_f32 v204, v228, v220
    v_sub_f32 v197, v213, v237
    v_add_f32 v205, v229, v221
    v_sub_f32 v198, v214, v238
    v_add_f32 v206, v230, v222
    v_sub_f32 v199, v215, v239
    v_add_f32 v207, v231, v223
    s_cmp_eq_u32 s79, 0
    s_cbranch_scc0 L_nospecial
    s_mov_b32 exec_hi, 0
    v_mov_b32 v192, v208
    v_mov_b32 v200, v224
    v_cvt_pk_bf16_f32 v8, v216, v232
    buffer_store_dword v8, v15, s[44:47], s80 offen offset:1024 sc1
    s_mov_b64 exec, -1
L_nospecial:
    v_cvt_pk_bf16_f32 v208, v192, v200
    v_cvt_pk_bf16_f32 v209, v193, v201
    v_cvt_pk_bf16_f32 v210, v194, v202
    v_cvt_pk_bf16_f32 v211, v195, v203
    v_cvt_pk_bf16_f32 v212, v196, v204
    v_cvt_pk_bf16_f32 v213, v197, v205
    v_cvt_pk_bf16_f32 v214, v198, v206
    v_cvt_pk_bf16_f32 v215, v199, v207
    s_setprio 0
    ds_write_b128 v250, v[208:211] offset:8192
    ds_write_b128 v253, v[212:215] offset:8192
    s_waitcnt lgkmcnt(0)
    ds_read_b128 v[216:219], v16 offset:8192
    ds_read_b128 v[220:223], v16 offset:9216
    s_add_u32 s81, s80, 1179648
    s_waitcnt lgkmcnt(0)
    buffer_store_dwordx4 v[216:219], v17, s[44:47], s80 offen sc1
    buffer_store_dwordx4 v[220:223], v17, s[44:47], s81 offen sc1
    s_add_u32 m0, s30, 8192
    s_add_u32 s81, s96, 0
    buffer_load_dwordx4 v14, s[48:51], s81 offen lds
    s_add_u32 m0, s30, 9216
    s_add_u32 s81, s96, 8192
    buffer_load_dwordx4 v14, s[48:51], s81 offen lds
    s_add_u32 m0, s30, 16384
    s_add_u32 s81, s96, 65536
    buffer_load_dwordx4 v14, s[48:51], s81 offen lds
    s_add_u32 m0, s30, 17408
    s_add_u32 s81, s96, 73728
    buffer_load_dwordx4 v14, s[48:51], s81 offen lds
    s_lshl_b32 s81, s2, 7
    s_add_u32 s81, s81, 4751360
    s_waitcnt vmcnt(4)
    s_setprio 2
    v_mov_b32 v8, 156676
    v_mov_b32 v9, 1
    s_mov_b64 exec, 1
    ds_add_rtn_u32 v9, v8, v9
    v_mov_b32 v10, s86
    v_mov_b32 v11, s87
    s_waitcnt lgkmcnt(0)
    v_readfirstlane_b32 s84, v9
    s_nop 0
    s_cmp_eq_u32 s84, 3
    s_cbranch_scc0 L_sigH_nf
    buffer_store_dwordx2 v[10:11], off, s[44:47], s81 sc1
L_sigH_nf:
    s_mov_b64 exec, -1
    s_setprio 0
    buffer_load_dwordx4 v[144:147], v251, s[56:59], 0 offen offset:0
    buffer_load_dwordx4 v[148:151], v251, s[56:59], 0 offen offset:16
    buffer_load_dwordx4 v[152:155], v251, s[56:59], 0 offen offset:32
    buffer_load_dwordx4 v[156:159], v251, s[56:59], 0 offen offset:48
    buffer_load_dwordx4 v[160:163], v252, s[60:63], 0 offen offset:0
    buffer_load_dwordx4 v[164:167], v252, s[60:63], 0 offen offset:16
    buffer_load_dwordx4 v[168:171], v252, s[60:63], 0 offen offset:32
    buffer_load_dwordx4 v[172:175], v252, s[60:63], 0 offen offset:48
    s_waitcnt vmcnt(10) lgkmcnt(0)
    s_mov_b64 exec, 1
    ds_add_u32 v248, v249 offset:8
    s_mov_b64 exec, -1
    s_mov_b32 s91, 3200000
L_st16:
    ds_read_b32 v8, v248 offset:8
    s_sub_u32 s91, s91, 1
    s_cbranch_scc1 L_st16_done
    s_waitcnt lgkmcnt(0)
    v_readfirstlane_b32 s84, v8
    s_setprio 0
    s_cmp_ge_u32 s84, 68
    s_cbranch_scc1 L_st16_done
    s_sleep 1
    s_branch L_st16
L_st16_done:
    s_add_u32 m0, s30, 0
    s_add_u32 s81, s96, 131072
    buffer_load_dwordx4 v14, s[48:51], s81 offen lds
    s_add_u32 m0, s30, 1024
    s_add_u32 s81, s96, 139264
    buffer_load_dwordx4 v14, s[48:51], s81 offen lds
    ds_read_b64_tr_b16 v[16:17], v0 offset:8192
    ds_read_b64_tr_b16 v[18:19], v0 offset:8704
    ds_read_b64_tr_b16 v[20:21], v0 offset:10240
    ds_read_b64_tr_b16 v[22:23], v0 offset:10752
    ds_read_b64_tr_b16 v[24:25], v0 offset:12288
    ds_read_b64_tr_b16 v[26:27], v0 offset:12800
    ds_read_b64_tr_b16 v[28:29], v0 offset:14336
    ds_read_b64_tr_b16 v[30:31], v0 offset:14848
    s_waitcnt vmcnt(10) lgkmcnt(0)
    s_mov_b64 exec, 1
    ds_add_u32 v248, v249 offset:8
    s_mov_b64 exec, -1
    s_mov_b32 s91, 3200000
L_st17:
    ds_read_b32 v8, v248 offset:8
    s_sub_u32 s91, s91, 1
    s_cbranch_scc1 L_st17_done
    s_waitcnt lgkmcnt(0)
    v_readfirstlane_b32 s84, v8
    s_setprio 0
    s_cmp_ge_u32 s84, 72
    s_cbranch_scc1 L_st17_done
    s_sleep 1
    s_branch L_st17
L_st17_done:
    s_add_u32 m0, s30, 8192
    s_add_u32 s81, s96, 196608
    buffer_load_dwordx4 v14, s[48:51], s81 offen lds
    s_add_u32 m0, s30, 9216
    s_add_u32 s81, s96, 204800
    buffer_load_dwordx4 v14, s[48:51], s81 offen lds
    ds_read_b64_tr_b16 v[32:33], v0 offset:16384
    ds_read_b64_tr_b16 v[34:35], v0 offset:16896
    ds_read_b64_tr_b16 v[36:37], v0 offset:18432
    ds_read_b64_tr_b16 v[38:39], v0 offset:18944
    ds_read_b64_tr_b16 v[40:41], v0 offset:20480
    ds_read_b64_tr_b16 v[42:43], v0 offset:20992
    ds_read_b64_tr_b16 v[44:45], v0 offset:22528
    ds_read_b64_tr_b16 v[46:47], v0 offset:23040
    s_waitcnt vmcnt(2) lgkmcnt(0)
    s_mov_b64 exec, 1
    ds_add_u32 v248, v249 offset:8
    s_mov_b64 exec, -1
    s_mov_b32 s91, 3200000
L_st18:
    ds_read_b32 v8, v248 offset:8
    s_sub_u32 s91, s91, 1
    s_cbranch_scc1 L_st18_done
    s_waitcnt lgkmcnt(0)
    v_readfirstlane_b32 s84, v8
    s_setprio 0
    s_cmp_ge_u32 s84, 76
    s_cbranch_scc1 L_st18_done
    s_sleep 1
    s_branch L_st18
L_st18_done:
    s_add_u32 m0, s30, 16384
    s_add_u32 s81, s96, 262144
    buffer_load_dwordx4 v14, s[48:51], s81 offen lds
    s_add_u32 m0, s30, 17408
    s_add_u32 s81, s96, 270336
    buffer_load_dwordx4 v14, s[48:51], s81 offen lds
    ds_read_b64_tr_b16 v[48:49], v0 offset:0
    ds_read_b64_tr_b16 v[50:51], v0 offset:512
    ds_read_b64_tr_b16 v[52:53], v0 offset:2048
    ds_read_b64_tr_b16 v[54:55], v0 offset:2560
    ds_read_b64_tr_b16 v[56:57], v0 offset:4096
    ds_read_b64_tr_b16 v[58:59], v0 offset:4608
    ds_read_b64_tr_b16 v[60:61], v0 offset:6144
    ds_read_b64_tr_b16 v[62:63], v0 offset:6656
    s_waitcnt vmcnt(2) lgkmcnt(0)
    s_mov_b64 exec, 1
    ds_add_u32 v248, v249 offset:8
    s_mov_b64 exec, -1
    s_mov_b32 s91, 3200000
L_st19:
    ds_read_b32 v8, v248 offset:8
    s_sub_u32 s91, s91, 1
    s_cbranch_scc1 L_st19_done
    s_waitcnt lgkmcnt(0)
    v_readfirstlane_b32 s84, v8
    s_setprio 0
    s_cmp_ge_u32 s84, 80
    s_cbranch_scc1 L_st19_done
    s_sleep 1
    s_branch L_st19
L_st19_done:
    s_add_u32 m0, s30, 0
    s_add_u32 s81, s96, 327680
    buffer_load_dwordx4 v14, s[48:51], s81 offen lds
    s_add_u32 m0, s30, 1024
    s_add_u32 s81, s96, 335872
    buffer_load_dwordx4 v14, s[48:51], s81 offen lds
    ds_read_b64_tr_b16 v[64:65], v0 offset:8192
    ds_read_b64_tr_b16 v[66:67], v0 offset:8704
    ds_read_b64_tr_b16 v[68:69], v0 offset:10240
    ds_read_b64_tr_b16 v[70:71], v0 offset:10752
    ds_read_b64_tr_b16 v[72:73], v0 offset:12288
    ds_read_b64_tr_b16 v[74:75], v0 offset:12800
    ds_read_b64_tr_b16 v[76:77], v0 offset:14336
    ds_read_b64_tr_b16 v[78:79], v0 offset:14848
    s_waitcnt vmcnt(2) lgkmcnt(0)
    s_mov_b64 exec, 1
    ds_add_u32 v248, v249 offset:8
    s_mov_b64 exec, -1
    s_mov_b32 s91, 3200000
L_st20:
    ds_read_b32 v8, v248 offset:8
    s_sub_u32 s91, s91, 1
    s_cbranch_scc1 L_st20_done
    s_waitcnt lgkmcnt(0)
    v_readfirstlane_b32 s84, v8
    s_setprio 0
    s_cmp_ge_u32 s84, 84
    s_cbranch_scc1 L_st20_done
    s_sleep 1
    s_branch L_st20
L_st20_done:
    s_add_u32 m0, s30, 8192
    s_add_u32 s81, s96, 393216
    buffer_load_dwordx4 v14, s[48:51], s81 offen lds
    s_add_u32 m0, s30, 9216
    s_add_u32 s81, s96, 401408
    buffer_load_dwordx4 v14, s[48:51], s81 offen lds
    ds_read_b64_tr_b16 v[80:81], v0 offset:16384
    ds_read_b64_tr_b16 v[82:83], v0 offset:16896
    ds_read_b64_tr_b16 v[84:85], v0 offset:18432
    ds_read_b64_tr_b16 v[86:87], v0 offset:18944
    ds_read_b64_tr_b16 v[88:89], v0 offset:20480
    ds_read_b64_tr_b16 v[90:91], v0 offset:20992
    ds_read_b64_tr_b16 v[92:93], v0 offset:22528
    ds_read_b64_tr_b16 v[94:95], v0 offset:23040
    s_waitcnt vmcnt(2) lgkmcnt(0)
    s_mov_b64 exec, 1
    ds_add_u32 v248, v249 offset:8
    s_mov_b64 exec, -1
    s_mov_b32 s91, 3200000
L_st21:
    ds_read_b32 v8, v248 offset:8
    s_sub_u32 s91, s91, 1
    s_cbranch_scc1 L_st21_done
    s_waitcnt lgkmcnt(0)
    v_readfirstlane_b32 s84, v8
    s_setprio 0
    s_cmp_ge_u32 s84, 88
    s_cbranch_scc1 L_st21_done
    s_sleep 1
    s_branch L_st21
L_st21_done:
    s_add_u32 m0, s30, 16384
    s_add_u32 s81, s96, 458752
    buffer_load_dwordx4 v14, s[48:51], s81 offen lds
    s_add_u32 m0, s30, 17408
    s_add_u32 s81, s96, 466944
    buffer_load_dwordx4 v14, s[48:51], s81 offen lds
    ds_read_b64_tr_b16 v[96:97], v0 offset:0
    ds_read_b64_tr_b16 v[98:99], v0 offset:512
    ds_read_b64_tr_b16 v[100:101], v0 offset:2048
    ds_read_b64_tr_b16 v[102:103], v0 offset:2560
    ds_read_b64_tr_b16 v[104:105], v0 offset:4096
    ds_read_b64_tr_b16 v[106:107], v0 offset:4608
    ds_read_b64_tr_b16 v[108:109], v0 offset:6144
    ds_read_b64_tr_b16 v[110:111], v0 offset:6656
    s_waitcnt vmcnt(2) lgkmcnt(0)
    s_mov_b64 exec, 1
    ds_add_u32 v248, v249 offset:8
    s_mov_b64 exec, -1
    s_mov_b32 s91, 3200000
L_st22:
    ds_read_b32 v8, v248 offset:8
    s_sub_u32 s91, s91, 1
    s_cbranch_scc1 L_st22_done
    s_waitcnt lgkmcnt(0)
    v_readfirstlane_b32 s84, v8
    s_setprio 0
    s_cmp_ge_u32 s84, 92
    s_cbranch_scc1 L_st22_done
    s_sleep 1
    s_branch L_st22
L_st22_done:
    ds_read_b64_tr_b16 v[112:113], v0 offset:8192
    ds_read_b64_tr_b16 v[114:115], v0 offset:8704
    ds_read_b64_tr_b16 v[116:117], v0 offset:10240
    ds_read_b64_tr_b16 v[118:119], v0 offset:10752
    ds_read_b64_tr_b16 v[120:121], v0 offset:12288
    ds_read_b64_tr_b16 v[122:123], v0 offset:12800
    ds_read_b64_tr_b16 v[124:125], v0 offset:14336
    ds_read_b64_tr_b16 v[126:127], v0 offset:14848
    s_waitcnt vmcnt(0) lgkmcnt(0)
    s_mov_b64 exec, 1
    ds_add_u32 v248, v249 offset:8
    s_mov_b64 exec, -1
    s_mov_b32 s91, 3200000
L_st23:
    ds_read_b32 v8, v248 offset:8
    s_sub_u32 s91, s91, 1
    s_cbranch_scc1 L_st23_done
    s_waitcnt lgkmcnt(0)
    v_readfirstlane_b32 s84, v8
    s_setprio 0
    s_cmp_ge_u32 s84, 96
    s_cbranch_scc1 L_st23_done
    s_sleep 1
    s_branch L_st23
L_st23_done:
    ds_read_b64_tr_b16 v[128:129], v0 offset:16384
    ds_read_b64_tr_b16 v[130:131], v0 offset:16896
    ds_read_b64_tr_b16 v[132:133], v0 offset:18432
    ds_read_b64_tr_b16 v[134:135], v0 offset:18944
    ds_read_b64_tr_b16 v[136:137], v0 offset:20480
    ds_read_b64_tr_b16 v[138:139], v0 offset:20992
    ds_read_b64_tr_b16 v[140:141], v0 offset:22528
    ds_read_b64_tr_b16 v[142:143], v0 offset:23040
    s_setprio 2
    s_cmp_eq_u32 s78, 2
    s_cbranch_scc0 L_nopre
    v_lshrrev_b32 v8, 5, v1
    v_and_b32 v9, 31, v1
    v_lshlrev_b32 v9, 7, v9
    v_lshl_add_u32 v8, v8, 15, v9
    s_lshl_b32 s80, s75, 16
    s_lshl_b32 s81, s76, 12
    s_add_u32 s80, s80, s81
    s_add_u32 s80, s80, 262144
    buffer_load_dword v10, v8, s[44:47], s80 offen sc1
    v_and_b32 v9, 0xf80, v7
    s_lshl_b32 s80, s75, 12
    s_add_u32 s80, s80, 4849664
    buffer_load_dword v11, v9, s[44:47], s80 offen sc1
    s_waitcnt vmcnt(0)
L_nopre:
    s_cmp_eq_u32 s78, 1
    s_cbranch_scc0 L_nosame
    v_and_b32 v8, 7, v1
    v_lshlrev_b32 v8, 12, v8
    s_and_b32 s80, s2, 31
    s_lshl_b32 s80, s80, 7
    s_add_u32 s80, s80, 4784128
    buffer_load_dwordx2 v[10:11], v8, s[44:47], s80 offen sc1
    s_getreg_b32 s92, hwreg(HW_REG_XCC_ID, 0, 4)
    s_or_b32 s92, s92, s86
    s_mov_b32 s93, s87
    v_mov_b32 v9, 156700
    s_waitcnt vmcnt(0)
    v_cmp_ne_u64 vcc, s[92:93], v[10:11]
    s_nop 0
    s_cmp_eq_u64 vcc, 0
    s_cselect_b32 s80, 1, 0
    v_mov_b32 v11, s80
    ds_write_b32 v9, v11
L_nosame:
    s_cmp_eq_u32 s78, 0
    s_cbranch_scc0 L_hwait
    s_lshr_b32 s82, s74, 2
    s_sub_u32 s80, 7, s82
    s_sub_u32 s81, 8, s82
    s_and_b32 s81, s81, 3
    s_cmp_lt_u32 s82, 4
    s_cselect_b32 s80, s82, s80
    s_cselect_b32 s81, s82, s81
    s_lshl_b32 s80, s80, 13
    s_lshl_b32 s81, s81, 13
    s_add_u32 s80, s80, 4751360
    s_add_u32 s81, s81, 4751360
    s_mov_b32 s91, 400000
L_pollH:
    buffer_load_dwordx2 v[8:9], v7, s[44:47], s80 offen sc1
    buffer_load_dwordx2 v[10:11], v7, s[44:47], s81 offen sc1
    s_sub_u32 s91, s91, 1
    s_cmp_eq_u32 s91, 0
    s_cbranch_scc1 L_pollH_done
    s_waitcnt vmcnt(0)
    v_cmp_ne_u64 vcc, s[86:87], v[8:9]
    v_cmp_ne_u64 s[92:93], s[86:87], v[10:11]
    s_nop 0
    s_or_b64 vcc, vcc, s[92:93]
    s_nop 0
    s_cmp_eq_u64 vcc, 0
    s_cbranch_scc1 L_pollH_done
    s_sleep 8
    s_branch L_pollH
L_pollH_done:
    s_waitcnt vmcnt(0)
    v_mov_b32 v10, 156696
    v_mov_b32 v11, 1
    ds_write_b32 v10, v11
    s_branch L_hok
L_hwait:
    s_mov_b32 s91, 3200000
    v_mov_b32 v10, 156696
L_hw:
    ds_read_b32 v11, v10
    s_sub_u32 s91, s91, 1
    s_cmp_eq_u32 s91, 0
    s_cbranch_scc1 L_hw_done
    s_waitcnt lgkmcnt(0)
    v_readfirstlane_b32 s84, v11
    s_nop 0
    s_cmp_ge_u32 s84, 1
    s_cbranch_scc1 L_hw_done
    s_sleep 8
    s_branch L_hw
L_hw_done:
    s_waitcnt lgkmcnt(0)
L_hok:
    s_setprio 0
    s_mul_i32 s80, s98, 73728
    s_add_u32 s80, s80, 2359296
    buffer_load_dword v208, v4, s[44:47], s80 offen offset:0 sc1
    buffer_load_dword v209, v4, s[44:47], s80 offen offset:1152 sc1
    buffer_load_dword v210, v4, s[44:47], s80 offen offset:2304 sc1
    buffer_load_dword v211, v4, s[44:47], s80 offen offset:3456 sc1
    s_add_u32 s80, s80, 4608
    buffer_load_dword v212, v4, s[44:47], s80 offen offset:0 sc1
    buffer_load_dword v213, v4, s[44:47], s80 offen offset:1152 sc1
    buffer_load_dword v214, v4, s[44:47], s80 offen offset:2304 sc1
    buffer_load_dword v215, v4, s[44:47], s80 offen offset:3456 sc1
    s_add_u32 s80, s80, 4608
    buffer_load_dword v216, v4, s[44:47], s80 offen offset:0 sc1
    buffer_load_dword v217, v4, s[44:47], s80 offen offset:1152 sc1
    buffer_load_dword v218, v4, s[44:47], s80 offen offset:2304 sc1
    buffer_load_dword v219, v4, s[44:47], s80 offen offset:3456 sc1
    s_add_u32 s80, s80, 4608
    buffer_load_dword v220, v4, s[44:47], s80 offen offset:0 sc1
    buffer_load_dword v221, v4, s[44:47], s80 offen offset:1152 sc1
    buffer_load_dword v222, v4, s[44:47], s80 offen offset:2304 sc1
    buffer_load_dword v223, v4, s[44:47], s80 offen offset:3456 sc1
    s_add_u32 s80, s80, 4608
    buffer_load_dword v224, v4, s[44:47], s80 offen offset:0 sc1
    buffer_load_dword v225, v4, s[44:47], s80 offen offset:1152 sc1
    buffer_load_dword v226, v4, s[44:47], s80 offen offset:2304 sc1
    buffer_load_dword v227, v4, s[44:47], s80 offen offset:3456 sc1
    s_add_u32 s80, s80, 4608
    buffer_load_dword v228, v4, s[44:47], s80 offen offset:0 sc1
    buffer_load_dword v229, v4, s[44:47], s80 offen offset:1152 sc1
    buffer_load_dword v230, v4, s[44:47], s80 offen offset:2304 sc1
    buffer_load_dword v231, v4, s[44:47], s80 offen offset:3456 sc1
    s_add_u32 s80, s80, 4608
    buffer_load_dword v232, v4, s[44:47], s80 offen offset:0 sc1
    buffer_load_dword v233, v4, s[44:47], s80 offen offset:1152 sc1
    buffer_load_dword v234, v4, s[44:47], s80 offen offset:2304 sc1
    buffer_load_dword v235, v4, s[44:47], s80 offen offset:3456 sc1
    s_add_u32 s80, s80, 4608
    buffer_load_dword v236, v4, s[44:47], s80 offen offset:0 sc1
    buffer_load_dword v237, v4, s[44:47], s80 offen offset:1152 sc1
    buffer_load_dword v238, v4, s[44:47], s80 offen offset:2304 sc1
    buffer_load_dword v239, v4, s[44:47], s80 offen offset:3456 sc1
L_b2done:
    s_setprio 0
    s_waitcnt vmcnt(0) lgkmcnt(0)
    s_barrier
    s_mov_b32 s82, 0x05040100
    s_mov_b32 s83, 0x07060302
    v_perm_b32 v176, v160, v144, s82
    v_perm_b32 v177, v160, v144, s83
    v_perm_b32 v178, v161, v145, s82
    v_perm_b32 v179, v161, v145, s83
    v_perm_b32 v180, v162, v146, s82
    v_perm_b32 v181, v162, v146, s83
    v_perm_b32 v182, v163, v147, s82
    v_perm_b32 v183, v163, v147, s83
    v_perm_b32 v184, v164, v148, s82
    v_perm_b32 v185, v164, v148, s83
    v_perm_b32 v186, v165, v149, s82
    v_perm_b32 v187, v165, v149, s83
    v_perm_b32 v188, v166, v150, s82
    v_perm_b32 v189, v166, v150, s83
    v_perm_b32 v190, v167, v151, s82
    v_perm_b32 v191, v167, v151, s83
    v_perm_b32 v144, v168, v152, s82
    v_perm_b32 v145, v168, v152, s83
    v_perm_b32 v146, v169, v153, s82
    v_perm_b32 v147, v169, v153, s83
    v_perm_b32 v148, v170, v154, s82
    v_perm_b32 v149, v170, v154, s83
    v_perm_b32 v150, v171, v155, s82
    v_perm_b32 v151, v171, v155, s83
    v_perm_b32 v160, v172, v156, s82
    v_perm_b32 v161, v172, v156, s83
    v_perm_b32 v162, v173, v157, s82
    v_perm_b32 v163, v173, v157, s83
    v_perm_b32 v164, v174, v158, s82
    v_perm_b32 v165, v174, v158, s83
    v_perm_b32 v166, v175, v159, s82
    v_perm_b32 v167, v175, v159, s83
    s_lshl_b32 s88, s99, 6
    s_add_u32 s88, s88, 1024
    v_mfma_f32_32x32x16_bf16 v[192:207], v[208:211], v[176:179], 0
    v_mfma_f32_32x32x16_bf16 v[192:207], v[212:215], v[180:183], v[192:207]
    v_mfma_f32_32x32x16_bf16 v[192:207], v[216:219], v[184:187], v[192:207]
    v_mfma_f32_32x32x16_bf16 v[192:207], v[220:223], v[188:191], v[192:207]
    v_mfma_f32_32x32x16_bf16 v[192:207], v[224:227], v[144:147], v[192:207]
    v_mfma_f32_32x32x16_bf16 v[192:207], v[228:231], v[148:151], v[192:207]
    v_mfma_f32_32x32x16_bf16 v[192:207], v[232:235], v[160:163], v[192:207]
    v_mfma_f32_32x32x16_bf16 v[192:207], v[236:239], v[164:167], v[192:207]
    s_nop 11
    v_cvt_pk_bf16_f32 v216, v192, v193
    v_cvt_pk_bf16_f32 v217, v194, v195
    v_cvt_pk_bf16_f32 v218, v196, v197
    v_cvt_pk_bf16_f32 v219, v198, v199
    v_cvt_pk_bf16_f32 v220, v200, v201
    v_cvt_pk_bf16_f32 v221, v202, v203
    v_cvt_pk_bf16_f32 v222, v204, v205
    v_cvt_pk_bf16_f32 v223, v206, v207
    s_mov_b32 s80, s31
    s_barrier
    ds_read_b128 v[144:147], v5 offset:0
    ds_read_b128 v[148:151], v5 offset:1024
    ds_read_b128 v[152:155], v5 offset:8192
    ds_read_b128 v[156:159], v5 offset:9216
    ds_read_b128 v[160:163], v5 offset:16384
    s_waitcnt lgkmcnt(4)
    v_mfma_f32_32x32x16_bf16 v[192:207], v[16:19], v[144:147], 0
    ds_read_b128 v[164:167], v5 offset:17408
    s_waitcnt lgkmcnt(4)
    v_mfma_f32_32x32x16_bf16 v[192:207], v[20:23], v[148:151], v[192:207]
    ds_read_b128 v[168:171], v5 offset:24576
    s_waitcnt lgkmcnt(4)
    v_mfma_f32_32x32x16_bf16 v[192:207], v[48:51], v[152:155], v[192:207]
    ds_read_b128 v[172:175], v5 offset:25600
    s_waitcnt lgkmcnt(4)
    v_mfma_f32_32x32x16_bf16 v[192:207], v[52:55], v[156:159], v[192:207]
    s_barrier
    buffer_store_dwordx4 v[216:219], v3, s[64:67], s88 offen
    buffer_store_dwordx4 v[220:223], v3, s[64:67], s88 offen offset:16
    ds_read_b128 v[144:147], v5 offset:2048
    s_waitcnt lgkmcnt(4)
    v_mfma_f32_32x32x16_bf16 v[192:207], v[80:83], v[160:163], v[192:207]
    ds_read_b128 v[148:151], v5 offset:3072
    s_waitcnt lgkmcnt(4)
    v_mfma_f32_32x32x16_bf16 v[192:207], v[84:87], v[164:167], v[192:207]
    ds_read_b128 v[152:155], v5 offset:10240
    s_waitcnt lgkmcnt(4)
    v_mfma_f32_32x32x16_bf16 v[192:207], v[112:115], v[168:171], v[192:207]
    ds_read_b128 v[156:159], v5 offset:11264
    s_waitcnt lgkmcnt(4)
    v_mfma_f32_32x32x16_bf16 v[192:207], v[116:119], v[172:175], v[192:207]
    ds_read_b128 v[160:163], v5 offset:18432
    s_waitcnt lgkmcnt(4)
    v_mfma_f32_32x32x16_bf16 v[192:207], v[24:27], v[144:147], v[192:207]
    ds_read_b128 v[164:167], v5 offset:19456
    s_waitcnt lgkmcnt(4)
    v_mfma_f32_32x32x16_bf16 v[192:207], v[28:31], v[148:151], v[192:207]
    ds_read_b128 v[168:171], v5 offset:26624
    s_waitcnt lgkmcnt(4)
    v_mfma_f32_32x32x16_bf16 v[192:207], v[56:59], v[152:155], v[192:207]
    ds_read_b128 v[172:175], v5 offset:27648
    s_waitcnt lgkmcnt(4)
    v_mfma_f32_32x32x16_bf16 v[192:207], v[60:63], v[156:159], v[192:207]
    s_barrier
    ds_read_b128 v[144:147], v5 offset:4096
    s_waitcnt lgkmcnt(4)
    v_mfma_f32_32x32x16_bf16 v[192:207], v[88:91], v[160:163], v[192:207]
    ds_read_b128 v[148:151], v5 offset:5120
    s_waitcnt lgkmcnt(4)
    v_mfma_f32_32x32x16_bf16 v[192:207], v[92:95], v[164:167], v[192:207]
    ds_read_b128 v[152:155], v5 offset:12288
    s_waitcnt lgkmcnt(4)
    v_mfma_f32_32x32x16_bf16 v[192:207], v[120:123], v[168:171], v[192:207]
    ds_read_b128 v[156:159], v5 offset:13312
    s_waitcnt lgkmcnt(4)
    v_mfma_f32_32x32x16_bf16 v[192:207], v[124:127], v[172:175], v[192:207]
    ds_read_b128 v[160:163], v5 offset:20480
    s_waitcnt lgkmcnt(4)
    v_mfma_f32_32x32x16_bf16 v[192:207], v[32:35], v[144:147], v[192:207]
    ds_read_b128 v[164:167], v5 offset:21504
    s_waitcnt lgkmcnt(4)
    v_mfma_f32_32x32x16_bf16 v[192:207], v[36:39], v[148:151], v[192:207]
    ds_read_b128 v[168:171], v5 offset:28672
    s_waitcnt lgkmcnt(4)
    v_mfma_f32_32x32x16_bf16 v[192:207], v[64:67], v[152:155], v[192:207]
    ds_read_b128 v[172:175], v5 offset:29696
    s_waitcnt lgkmcnt(4)
    v_mfma_f32_32x32x16_bf16 v[192:207], v[68:71], v[156:159], v[192:207]
    s_barrier
    ds_read_b128 v[144:147], v5 offset:6144
    s_waitcnt lgkmcnt(4)
    v_mfma_f32_32x32x16_bf16 v[192:207], v[96:99], v[160:163], v[192:207]
    ds_read_b128 v[148:151], v5 offset:7168
    s_waitcnt lgkmcnt(4)
    v_mfma_f32_32x32x16_bf16 v[192:207], v[100:103], v[164:167], v[192:207]
    ds_read_b128 v[152:155], v5 offset:14336
    s_waitcnt lgkmcnt(4)
    v_mfma_f32_32x32x16_bf16 v[192:207], v[128:131], v[168:171], v[192:207]
    ds_read_b128 v[156:159], v5 offset:15360
    s_waitcnt lgkmcnt(4)
    v_mfma_f32_32x32x16_bf16 v[192:207], v[132:135], v[172:175], v[192:207]
    ds_read_b128 v[160:163], v5 offset:22528
    s_waitcnt lgkmcnt(4)
    v_mfma_f32_32x32x16_bf16 v[192:207], v[40:43], v[144:147], v[192:207]
    ds_read_b128 v[164:167], v5 offset:23552
    s_waitcnt lgkmcnt(4)
    v_mfma_f32_32x32x16_bf16 v[192:207], v[44:47], v[148:151], v[192:207]
    ds_read_b128 v[168:171], v5 offset:30720
    s_waitcnt lgkmcnt(4)
    v_mfma_f32_32x32x16_bf16 v[192:207], v[72:75], v[152:155], v[192:207]
    ds_read_b128 v[172:175], v5 offset:31744
    s_waitcnt lgkmcnt(4)
    v_mfma_f32_32x32x16_bf16 v[192:207], v[76:79], v[156:159], v[192:207]
    s_waitcnt lgkmcnt(3)
    v_mfma_f32_32x32x16_bf16 v[192:207], v[104:107], v[160:163], v[192:207]
    s_waitcnt lgkmcnt(2)
    v_mfma_f32_32x32x16_bf16 v[192:207], v[108:111], v[164:167], v[192:207]
    s_waitcnt lgkmcnt(1)
    v_mfma_f32_32x32x16_bf16 v[192:207], v[136:139], v[168:171], v[192:207]
    s_waitcnt lgkmcnt(0)
    v_mfma_f32_32x32x16_bf16 v[192:207], v[140:143], v[172:175], v[192:207]
    s_nop 11
    v_cvt_pk_bf16_f32 v208, v192, v193
    v_cvt_pk_bf16_f32 v209, v194, v195
    v_cvt_pk_bf16_f32 v210, v196, v197
    v_cvt_pk_bf16_f32 v211, v198, v199
    v_cvt_pk_bf16_f32 v212, v200, v201
    v_cvt_pk_bf16_f32 v213, v202, v203
    v_cvt_pk_bf16_f32 v214, v204, v205
    v_cvt_pk_bf16_f32 v215, v206, v207
    buffer_store_dwordx4 v[208:211], v6, s[64:67], s80 offen
    buffer_store_dwordx4 v[212:215], v6, s[64:67], s80 offen offset:16
L_end:
    s_endpgm
L_codeend:
.section .rodata,"a"
.p2align 6
.amdhsa_kernel concat_heads__grouped_kv_mqa__spectral_fnet__prompt_kernel
  .amdhsa_next_free_vgpr 256
  .amdhsa_next_free_sgpr 102
  .amdhsa_accum_offset 256
  .amdhsa_group_segment_fixed_size 0
  .amdhsa_kernarg_size 104
  .amdhsa_user_sgpr_count 2
  .amdhsa_user_sgpr_kernarg_segment_ptr 1
  .amdhsa_system_sgpr_workgroup_id_x 1
.end_amdhsa_kernel
```
